```python
import torch

def _softmax(x, axis=-1):
    return torch.softmax(x, dim=axis)
def _gelu(x):
    return torch.nn.functional.gelu(x, approximate="tanh")
def _silu(x):
    return torch.nn.functional.silu(x)
def _sigmoid(x):
    return torch.sigmoid(x)
def _layernorm(x, axis=-1, eps=1e-5):
    m = x.mean(dim=axis, keepdim=True)
    v = x.var(dim=axis, keepdim=True, unbiased=False)
    return (x - m) / torch.sqrt(v + eps)
def _scatter_add(tgt, idx, src, axis=0):
    return tgt.clone().index_add_(axis, idx, src)
def _segment_sum(src, seg, n):
    out = torch.zeros((n,) + src.shape[1:], dtype=src.dtype)
    return out.index_add_(0, seg, src)
def _pad(x, pw):
    flat = tuple(v for pair in reversed(pw) for v in pair)
    return torch.nn.functional.pad(x, flat)

kernel_name = 'gated_mix__spectral_fnet__sliding_local_dilated__prompt'

def setup_inputs():

    _w = (lambda a: (lambda t: t.to(torch.bfloat16) if t.is_floating_point() else t)(torch.as_tensor(a)))
    def _A_setup():
        B, S, D = 1, 2048, 448
        ns = torch.arange(S)[:, None] * torch.arange(S)[None, :]
        nd = torch.arange(D)[:, None] * torch.arange(D)[None, :]
        Ws_re = torch.cos(-2.0 * torch.pi * ns / S).to(float)
        Ws_im = torch.sin(-2.0 * torch.pi * ns / S).to(float)
        Wd_re = torch.cos(-2.0 * torch.pi * nd / D).to(float)
        Wd_im = torch.sin(-2.0 * torch.pi * nd / D).to(float)
        return {
            "x": _w((lambda *s: torch.randn(*s, dtype=torch.bfloat16) * 0.05)(B, S, D)),
            "dft_seq_re": _w(Ws_re),
            "dft_seq_im": _w(Ws_im),
            "dft_hid_re": _w(Wd_re),
            "dft_hid_im": _w(Wd_im),
        }
    _A_in = _A_setup()

    def _B_setup():
        B, S, D = 1, 2048, 448
        return {
            "x": _w((lambda *s: torch.randn(*s, dtype=torch.bfloat16) * 0.05)(B, S, D)),
            "wqkv": _w((lambda *s: torch.randn(*s, dtype=torch.bfloat16) * 1.6)(D, 3 * D)),
            "wo": _w((lambda *s: torch.randn(*s, dtype=torch.bfloat16) * 0.2)(D, D)),
        }
    _B_in = _B_setup()

    return {
        "A_x": _A_in["x"],
        "A_dft_seq_re": _A_in["dft_seq_re"],
        "A_dft_seq_im": _A_in["dft_seq_im"],
        "A_dft_hid_re": _A_in["dft_hid_re"],
        "A_dft_hid_im": _A_in["dft_hid_im"],
        "B_x": _B_in["x"],
        "B_wqkv": _B_in["wqkv"],
        "B_wo": _B_in["wo"],
        "gate_w": _w((lambda *s: torch.randn(*s, dtype=torch.bfloat16) * 0.05)(448) * 16.0),
    }

def reference(A_x, A_dft_seq_re, A_dft_seq_im, A_dft_hid_re, A_dft_hid_im, B_x, B_wqkv, B_wo, gate_w):
    def _A_ref(x, dft_seq_re, dft_seq_im, dft_hid_re, dft_hid_im):
        a = torch.einsum("bsd,ed->bse", x, dft_hid_re)
        b = torch.einsum("bsd,ed->bse", x, dft_hid_im)
        y = torch.einsum("ts,bse->bte", dft_seq_re, a) - torch.einsum("ts,bse->bte", dft_seq_im, b)
        return y

    def _B_ref(x, wqkv, wo):
        B, S, D = x.shape
        H = 16; Dh = D // H
        W, dil = 8, 2
        qkv = (lambda x, *d: x.permute(*d))((x @ wqkv).reshape(B, S, 3, H, Dh), 2, 0, 3, 1, 4)
        q, k, v = qkv[0], qkv[1], qkv[2]
        scale = Dh ** -0.5
        pos = torch.arange(S)
        off = torch.arange(W) * dil
        idx = pos[:, None] - off[None, :]
        mask = idx >= 0
        idx_c = torch.where(mask, idx, 0).reshape(-1)
        kg = k[:, :, idx_c, :].reshape(B, H, S, W, Dh)
        vg = v[:, :, idx_c, :].reshape(B, H, S, W, Dh)
        logits = torch.einsum("bhsd,bhswd->bhsw", q, kg) * scale
        logits = torch.where(mask[None, None, :, :], logits, -1e9)
        attn = _softmax(logits, axis=-1)
        o = torch.einsum("bhsw,bhswd->bhsd", attn, vg)
        return (lambda x, *d: x.permute(*d))(o, 0, 2, 1, 3).reshape(B, S, D) @ wo

    x = A_x
    g = _sigmoid((x * gate_w).sum(-1, keepdims=True))
    a = _A_ref(x, A_dft_seq_re, A_dft_seq_im, A_dft_hid_re, A_dft_hid_im)
    b = _B_ref(x, B_wqkv, B_wo)
    return g * a + (1 - g) * b
```

```asm
; @launch grid=(256,1,1) block=(256,1,1) lds=155648
.amdgcn_target "amdgcn-amd-amdhsa--gfx950"
.text
.p2align 8
.globl gated_mix__spectral_fnet__sliding_local_dilated__prompt_kernel
.type gated_mix__spectral_fnet__sliding_local_dilated__prompt_kernel,@function
gated_mix__spectral_fnet__sliding_local_dilated__prompt_kernel:
s_cmp_ge_u32 s2, 256
s_cbranch_scc1 L_end
s_load_dwordx16 s[4:19], s[0:1], 0
s_load_dwordx8 s[20:27], s[0:1], 64
s_cmp_ge_u32 s2, 8
s_cbranch_scc1 L_nocp
s_getpc_b64 s[90:91]
L_pc:
v_lshlrev_b32 v2, 7, v0
v_mov_b32 v3, s91
v_add_co_u32 v2, vcc, s90, v2
v_addc_co_u32 v3, vcc, 0, v3, vcc
v_cmp_gt_u32 vcc, (L_end - L_pc) / 128, v0
s_and_saveexec_b64 s[90:91], vcc
s_cbranch_execz L_cp2
global_load_dword v206, v[2:3], off
L_cp2:
s_mov_b64 exec, -1
L_nocp:
s_memrealtime s[92:93]
v_lshrrev_b32 v2, 6, v0
v_and_b32 v1, 63, v0
s_and_b32 s45, s2, 1
v_readfirstlane_b32 s44, v2
s_bfe_u32 s46, s2, 0x20001
s_lshr_b32 s47, s2, 3
s_waitcnt lgkmcnt(0)
s_mov_b32 s40, s26
s_mov_b32 s41, s27
s_mov_b32 s42, 6291456
s_mov_b32 s43, 0x20000
s_movk_i32 s26, 256
s_mov_b32 s27, 0x20000
s_or_b32 s88, s2, s44
s_cbranch_scc1 L_nopub
s_or_b32 s92, s92, 1
v_mov_b32 v3, s92
s_mov_b64 exec, 1
buffer_store_dword v3, off, s[24:27], 0 sc1
s_mov_b64 exec, -1
L_nopub:
s_cmp_ge_u32 s47, 24
s_cbranch_scc1 L_dft
s_mov_b32 s28, s4
s_mov_b32 s29, s5
s_mov_b32 s30, 1835008
s_mov_b32 s31, 0x20000
s_mov_b32 s32, s16
s_mov_b32 s33, s17
s_mov_b32 s34, 1204224
s_mov_b32 s35, 0x20000
s_and_b32 s48, s47, 1
s_lshl_b32 s49, s46, 1
s_add_u32 s48, s48, s49
s_lshr_b32 s49, s47, 1
s_lshr_b32 s50, s44, 1
s_and_b32 s51, s44, 1
v_lshrrev_b32 v2, 3, v1
v_and_b32 v3, 7, v1
v_lshrrev_b32 v4, 1, v2
v_lshlrev_b32 v5, 1, v4
v_xor_b32 v5, v3, v5
v_lshrrev_b32 v6, 2, v2
v_and_b32 v7, 3, v2
v_lshl_add_u32 v6, v6, 3, v7
s_lshl_b32 s52, s50, 5
s_lshl_b32 s53, s51, 2
s_add_u32 s52, s52, s53
v_add_u32 v6, s52, v6
s_movk_i32 s53, 2688
s_mul_i32 s54, s48, 112
v_mul_u32_u24 v6, s53, v6
v_lshl_add_u32 v6, v5, 4, v6
v_add_u32 v6, s54, v6
v_cmp_eq_u32 vcc, 7, v5
v_bfrev_b32 v7, 1
s_mul_i32 s55, s50, 12288
v_cndmask_b32 v32, v6, v7, vcc
s_lshl_b32 s56, s51, 11
s_add_u32 s55, s55, s56
s_mul_i32 s56, s44, 3072
s_add_u32 s56, s56, 24576
s_mul_i32 s57, s49, 86
s_mul_i32 s58, s44, 24
s_add_u32 s57, s57, s58
s_sub_u32 s57, s57, 7
s_lshl_b32 s57, s57, 1
s_add_u32 s57, s57, s45
s_mul_i32 s57, s57, 896
s_movk_i32 s58, 1792
v_mul_u32_u24 v8, s58, v2
v_add_u32 v8, s57, v8
v_xor_b32 v9, v3, v4
s_lshl_b32 s59, s51, 2
v_xor_b32 v9, s59, v9
v_xor_b32 v10, 4, v9
v_lshl_add_u32 v33, v9, 4, v8
v_lshl_add_u32 v34, v10, 4, v8
v_add_u32 v34, 14336, v34
v_add_u32 v35, 28672, v33
s_lshl_b32 s59, s47, 2
s_add_u32 s59, s59, s44
s_mov_b32 s64, s16
s_mov_b32 s65, s17
s_mov_b32 s66, 1204224
s_mov_b32 s67, 0x20000
v_and_b32 v2, 15, v1
v_lshrrev_b32 v3, 4, v1
v_lshl_add_u32 v3, v3, 7, s59
v_mul_u32_u24 v4, 11, v2
v_lshrrev_b32 v4, 5, v4
s_movk_i32 s60, 2688
s_mul_i32 s61, s46, 224
v_mul_u32_u24 v3, s60, v3
v_mul_u32_u24 v2, 108, v2
v_mul_u32_u24 v4, 572, v4
s_mov_b32 exec_lo, 0x1ff01ff
v_add3_u32 v3, v3, v2, v4
s_mov_b32 exec_hi, 0x1ff01ff
buffer_load_dword v206, v3, s[64:67], s61 offen
s_mov_b64 exec, -1
s_add_u32 m0, s55, 0
s_mov_b32 s60, 0
buffer_load_dwordx4 v32, s[32:35], s60 offen offset:0  lds
s_add_u32 m0, s55, 3200
s_nop 0
buffer_load_dwordx4 v32, s[32:35], s60 offen offset:896  lds
s_add_u32 m0, s55, 6400
s_nop 0
buffer_load_dwordx4 v32, s[32:35], s60 offen offset:1792  lds
s_add_u32 m0, s55, 1024
s_mov_b32 s60, 43008
buffer_load_dwordx4 v32, s[32:35], s60 offen offset:0  lds
s_add_u32 m0, s55, 4224
s_nop 0
buffer_load_dwordx4 v32, s[32:35], s60 offen offset:896  lds
s_add_u32 m0, s55, 7424
s_nop 0
buffer_load_dwordx4 v32, s[32:35], s60 offen offset:1792  lds
s_add_u32 m0, s56, 0
s_nop 0
buffer_load_dwordx4 v33, s[28:31], 0 offen offset:0  lds
s_add_u32 m0, s56, 1024
s_nop 0
buffer_load_dwordx4 v34, s[28:31], 0 offen offset:0  lds
s_add_u32 m0, s56, 2048
s_nop 0
buffer_load_dwordx4 v35, s[28:31], 0 offen offset:0  lds
s_add_u32 m0, s55, 36864
s_mov_b32 s60, 172032
v_lshrrev_b32 v2, 4, v1
buffer_load_dwordx4 v32, s[32:35], s60 offen offset:0  lds
v_bfe_u32 v3, v1, 2, 2
v_and_b32 v4, 3, v1
v_and_b32 v5, 1, v2
v_lshl_add_u32 v5, v5, 2, v3
v_lshrrev_b32 v6, 1, v2
v_lshlrev_b32 v6, 10, v6
v_lshl_add_u32 v6, v5, 7, v6
v_and_b32 v7, 6, v5
s_mul_i32 s61, s51, 56
v_lshl_add_u32 v8, v4, 3, s61
v_add_u32 v9, 32, v8
v_lshrrev_b32 v10, 4, v8
v_xor_b32 v10, v10, v7
v_and_b32 v8, 8, v8
v_lshl_add_u32 v10, v10, 4, v8
v_add_u32 v16, v6, v10
v_lshrrev_b32 v10, 4, v9
v_xor_b32 v10, v10, v7
v_lshl_add_u32 v10, v10, 4, v8
s_add_u32 m0, s55, 40064
v_add_u32 v17, v6, v10
buffer_load_dwordx4 v32, s[32:35], s60 offen offset:896  lds
v_and_b32 v3, 15, v1
v_lshrrev_b32 v4, 1, v3
v_xor_b32 v4, v4, v2
s_mul_i32 s61, s50, 6144
s_add_u32 s61, s61, 24576
v_lshlrev_b32 v5, 7, v3
v_add_u32 v5, s61, v5
v_lshl_add_u32 v18, v4, 4, v5
v_xor_b32 v19, 64, v18
v_add_u32 v20, 36864, v16
v_add_u32 v21, 36864, v17
v_add_u32 v22, 36864, v18
v_add_u32 v23, 36864, v19
v_add_u32 v24, 73728, v16
v_add_u32 v25, 73728, v17
v_add_u32 v26, 73728, v18
v_add_u32 v27, 73728, v19
v_add_u32 v28, 110592, v16
v_add_u32 v29, 110592, v17
s_add_u32 m0, s55, 43264
v_add_u32 v30, 110592, v18
buffer_load_dwordx4 v32, s[32:35], s60 offen offset:1792  lds
v_add_u32 v31, 110592, v19
s_mul_i32 s61, s44, 3072
s_add_u32 s61, s61, 36864
v_lshrrev_b32 v4, 2, v3
v_xor_b32 v4, v4, v2
v_lshlrev_b32 v4, 4, v4
v_lshl_add_u32 v4, v3, 6, v4
v_add_u32 v14, s61, v4
v_xor_b32 v4, v1, v2
v_lshl_add_u32 v15, v4, 4, s61
v_lshrrev_b32 v3, 2, v1
s_mul_i32 s61, s50, 48
v_add_u32 v4, s61, v3
s_mul_i32 s62, s49, 86
s_sub_u32 s62, s62, 7
v_add_u32 v5, s62, v4
v_and_b32 v6, 15, v5
v_lshl_add_u32 v6, v6, 1, s45
v_ashrrev_i32 v7, 4, v5
s_add_u32 m0, s55, 37888
s_mov_b32 s60, 215040
v_lshl_add_u32 v6, v6, 6, v7
buffer_load_dwordx4 v32, s[32:35], s60 offen offset:0  lds
s_lshl_b32 s63, s48, 1
s_add_u32 s63, s63, s51
v_lshl_add_u32 v6, v6, 4, s63
v_and_b32 v7, 3, v1
v_lshl_add_u32 v6, v6, 2, v7
v_lshlrev_b32 v6, 4, v6
v_bfrev_b32 v7, 1
s_sub_u32 s63, 1031, s62
s_sub_u32 s63, s63, 14
s_min_u32 s63, s63, 86
v_add_u32 v8, -7, v4
v_cmp_gt_u32 vcc, s63, v8
v_add_u32 v9, 0, v6
s_nop 0
v_cndmask_b32 v11, v7, v9, vcc
v_add_u32 v8, 9, v4
v_cmp_gt_u32 vcc, s63, v8
v_add_u32 v9, 1024, v6
s_nop 0
s_add_u32 m0, s55, 41088
v_cndmask_b32 v12, v7, v9, vcc
buffer_load_dwordx4 v32, s[32:35], s60 offen offset:896  lds
v_add_u32 v8, 25, v4
v_cmp_gt_u32 vcc, s63, v8
v_add_u32 v9, 2048, v6
s_nop 0
v_cndmask_b32 v13, v7, v9, vcc
s_or_b32 s61, s49, s50
s_cmp_eq_u32 s61, 0
s_mov_b32 s72, 0xff000ff
s_cselect_b32 s72, 0x0, s72
s_mov_b32 s73, 0xf000ff00
s_mov_b32 s74, 0x1fe001fe
s_cselect_b32 s74, 0x0, s74
s_mov_b32 s75, 0xe000fe00
s_mov_b32 s76, 0x3fc003fc
s_cselect_b32 s76, 0x0, s76
s_mov_b32 s77, 0xc000fc00
s_mov_b32 s78, 0x7f8007f8
s_cselect_b32 s78, 0x7f800000, s78
s_mov_b32 s79, 0x8000f800
s_add_u32 m0, s55, 44288
s_mov_b32 s96, s18
buffer_load_dwordx4 v32, s[32:35], s60 offen offset:1792  lds
s_mov_b32 s97, s19
s_cmp_lt_u32 s2, 32
s_cselect_b32 s98, 0, 401408
s_mov_b32 s99, 0x20000
s_sub_u32 s88, s47, 4
s_mul_i32 s89, s88, 37
s_lshr_b32 s89, s89, 8
s_mul_i32 s89, s89, 7
s_sub_u32 s88, s88, s89
s_lshl_b32 s88, s88, 7
s_mul_i32 s89, s44, 7168
s_add_u32 s88, s88, s89
s_movk_i32 s89, 896
v_lshrrev_b32 v4, 3, v1
v_bfe_u32 v5, v1, 1, 2
v_lshrrev_b32 v6, 1, v4
v_xor_b32 v5, v5, v6
v_and_b32 v6, 1, v1
v_lshlrev_b32 v6, 4, v6
s_add_u32 m0, s56, 36736
v_lshl_add_u32 v5, v5, 5, v6
buffer_load_dwordx4 v33, s[28:31], 0 offen offset:128  lds
v_mad_u32_u24 v5, v4, s89, v5
v_add_u32 v204, s88, v5
s_lshl_b32 s100, s44, 10
s_lshl_b32 s88, s47, 2
s_add_u32 s88, s88, s44
s_mul_i32 s88, s88, 3136
v_lshl_add_u32 v207, v1, 7, s88
s_mov_b32 s3, 10240
s_mul_i32 s88, s46, 24
s_add_u32 s88, s88, s47
s_mul_i32 s89, s45, 160
s_add_u32 s88, s88, s89
s_sub_u32 s89, s2, 96
s_cmp_ge_u32 s47, 24
s_cselect_b32 s88, s89, s88
s_cselect_b32 s95, 5120, s3
s_cselect_b32 s3, -1, 0xffff
s_lshl_b32 s94, s88, 5
s_add_u32 s94, s94, 4259840
s_add_u32 m0, s56, 37760
s_mov_b32 s20, s22
buffer_load_dwordx4 v34, s[28:31], 0 offen offset:128  lds
s_mov_b32 s21, s23
s_mov_b32 s22, 1835008
s_mov_b32 s23, 0x20000
s_and_b32 s4, s2, 7
s_lshr_b32 s5, s2, 3
s_sub_u32 s5, s5, 4
s_mul_i32 s6, s5, 37
s_lshr_b32 s6, s6, 8
s_mul_i32 s7, s6, 7
s_sub_u32 s7, s5, s7
s_lshr_b32 s8, s6, 1
s_lshl_b32 s4, s4, 1
s_add_u32 s4, s4, s8
s_sub_u32 s8, 32, s4
s_cmp_eq_u32 s4, 0
s_cselect_b32 s8, 16, s8
s_bitcmp1_b32 s6, 0
s_cselect_b32 s4, s8, s4
s_sub_u32 s8, 32, s4
s_add_u32 m0, s56, 38784
s_and_b32 s8, s8, 31
buffer_load_dwordx4 v35, s[28:31], 0 offen offset:128  lds
s_lshl_b32 s9, s7, 2
s_add_u32 s9, s9, s44
s_lshl_b32 s9, s9, 4
v_and_b32 v3, 15, v1
v_lshrrev_b32 v2, 4, v1
v_add_u32 v4, s9, v3
v_sub_u32 v5, 448, v4
s_cmp_ge_u32 s9, 224
s_cselect_b32 s10, s8, s4
s_cselect_b64 vcc, -1, 0
s_lshl_b32 s10, s10, 16
s_add_u32 s10, s10, 2097152
v_cndmask_b32 v4, v4, v5, vcc
v_lshlrev_b32 v4, 4, v4
v_lshl_add_u32 v4, v2, 12, v4
v_add_u32 v244, s10, v4
s_lshl_b32 s11, s44, 4
v_add_u32 v4, s11, v3
v_lshlrev_b32 v5, 10, v2
s_add_u32 m0, s55, 73728
s_mov_b32 s60, 344064
v_lshl_add_u32 v5, v4, 4, v5
buffer_load_dwordx4 v32, s[32:35], s60 offen offset:0  lds
s_lshl_b32 s12, s4, 16
v_add_u32 v245, s12, v5
v_and_b32 v5, 1, v4
v_lshl_add_u32 v5, v5, 5, s4
v_lshlrev_b32 v5, 5, v5
v_lshrrev_b32 v6, 1, v4
v_add_u32 v5, v5, v6
v_lshlrev_b32 v5, 2, v5
v_add_u32 v246, 4194304, v5
v_lshl_add_u32 v248, v4, 5, s4
s_movk_i32 s12, 896
v_mul_u32_u24 v5, s12, v248
v_lshl_add_u32 v5, v2, 3, v5
s_lshl_b32 s13, s7, 7
v_add_u32 v247, s13, v5
s_lshl_b32 s16, s44, 12
s_add_u32 s16, s16, 61440
v_bfe_u32 v4, v1, 2, 4
v_bfe_u32 v5, v1, 3, 2
s_add_u32 m0, s55, 76928
v_and_b32 v6, 3, v1
buffer_load_dwordx4 v32, s[32:35], s60 offen offset:896  lds
v_lshlrev_b32 v6, 3, v6
v_lshl_add_u32 v6, v4, 7, v6
v_lshl_add_u32 v250, v5, 5, v6
v_xor_b32 v251, 32, v250
v_xor_b32 v252, 64, v250
v_xor_b32 v253, 96, v250
v_lshlrev_b32 v254, 4, v1
v_add_u32 v254, 61440, v254
s_mov_b32 s61, s4
s_mul_i32 s61, s61, 5120
s_add_u32 s61, s61, 4259840
v_lshl_add_u32 v240, v1, 5, s61
v_mov_b32 v242, s94
v_mad_u32_u24 v242, v1, s95, v242
v_lshrrev_b32 v4, 3, v1
v_and_b32 v5, 7, v1
v_lshrrev_b32 v6, 1, v4
v_xor_b32 v5, v5, v6
v_lshlrev_b32 v5, 4, v5
s_add_u32 m0, s55, 80128
v_lshl_add_u32 v5, v4, 10, v5
buffer_load_dwordx4 v32, s[32:35], s60 offen offset:1792  lds
s_lshl_b32 s61, s4, 16
s_lshl_b32 s62, s44, 14
s_add_u32 s61, s61, s62
v_add_u32 v245, s61, v5
v_xor_b32 v249, 64, v245
v_add_u32 v249, 8192, v249
s_add_u32 s15, s62, 77824
v_lshrrev_b32 v4, 1, v3
v_xor_b32 v4, v4, v2
v_lshlrev_b32 v4, 4, v4
v_lshl_add_u32 v4, v3, 7, v4
v_add_u32 v241, s15, v4
v_xor_b32 v243, 64, v241
s_lshl_b32 s61, s7, 2
s_add_u32 s61, s61, s44
s_mul_i32 s61, s61, 19
v_add_u32 v4, s61, v1
v_min_u32 v4, 511, v4
s_lshl_b32 s61, s4, 16
s_add_u32 m0, s55, 74752
s_mov_b32 s60, 387072
v_lshl_add_u32 v255, v4, 7, s61
buffer_load_dwordx4 v32, s[32:35], s60 offen offset:0  lds
v_cvt_f32_u32 v4, v248
v_mul_f32 v4, 0x3a000000, v4
v_lshrrev_b32 v5, 1, v2
v_lshlrev_b32 v5, 3, v5
v_and_b32 v6, 1, v2
v_add_u32 v5, v5, v6
v_cvt_f32_u32 v5, v5
s_cmp_gt_u32 s7, 3
s_cselect_b32 s17, 0x80008000, 0
s_cmp_ge_u32 s7, 3
s_cselect_b32 s18, 0x80008000, 0
v_add_f32 v60, 0x0, v5
v_add_f32 v61, 0x40000000, v5
v_add_f32 v62, 0x40800000, v5
v_add_f32 v63, 0x40c00000, v5
v_add_f32 v64, 0x41800000, v5
v_add_f32 v65, 0x41900000, v5
v_add_f32 v66, 0x41a00000, v5
v_add_f32 v67, 0x41b00000, v5
s_add_u32 m0, s55, 77952
v_mul_f32 v60, v4, v60
buffer_load_dwordx4 v32, s[32:35], s60 offen offset:896  lds
v_mul_f32 v61, v4, v61
v_mul_f32 v62, v4, v62
v_mul_f32 v63, v4, v63
v_mul_f32 v64, v4, v64
v_mul_f32 v65, v4, v65
v_mul_f32 v66, v4, v66
v_mul_f32 v67, v4, v67
v_fract_f32 v60, v60
v_fract_f32 v61, v61
v_fract_f32 v62, v62
v_fract_f32 v63, v63
v_fract_f32 v64, v64
v_fract_f32 v65, v65
v_fract_f32 v66, v66
v_fract_f32 v67, v67
v_cos_f32 v68, v60
v_cos_f32 v69, v61
v_cos_f32 v70, v62
v_cos_f32 v71, v63
s_add_u32 m0, s55, 81152
v_cos_f32 v72, v64
buffer_load_dwordx4 v32, s[32:35], s60 offen offset:1792  lds
v_cos_f32 v73, v65
v_cos_f32 v74, v66
v_cos_f32 v75, v67
v_sin_f32 v76, v60
v_sin_f32 v77, v61
v_sin_f32 v78, v62
v_sin_f32 v79, v63
v_sin_f32 v80, v64
v_sin_f32 v81, v65
v_sin_f32 v82, v66
v_sin_f32 v83, v67
v_cvt_pk_bf16_f32 v208, v68, v69
v_cvt_pk_bf16_f32 v209, v70, v71
v_cvt_pk_bf16_f32 v210, v76, v77
v_cvt_pk_bf16_f32 v211, v78, v79
v_mov_b32 v224, v208
v_mov_b32 v225, v209
v_xor_b32 v226, s18, v210
v_xor_b32 v227, s18, v211
s_add_u32 m0, s56, 73472
v_xor_b32 v210, s17, v210
buffer_load_dwordx4 v33, s[28:31], 0 offen offset:256  lds
v_xor_b32 v211, s17, v211
v_cvt_pk_bf16_f32 v212, v72, v73
v_cvt_pk_bf16_f32 v213, v74, v75
v_cvt_pk_bf16_f32 v214, v80, v81
v_cvt_pk_bf16_f32 v215, v82, v83
v_mov_b32 v228, v212
v_mov_b32 v229, v213
v_xor_b32 v230, s18, v214
v_xor_b32 v231, s18, v215
v_xor_b32 v214, s17, v214
v_xor_b32 v215, s17, v215
v_add_f32 v60, 0x42000000, v5
v_add_f32 v61, 0x42080000, v5
v_add_f32 v62, 0x42100000, v5
v_add_f32 v63, 0x42180000, v5
v_add_f32 v64, 0x42400000, v5
v_add_f32 v65, 0x42480000, v5
v_add_f32 v66, 0x42500000, v5
v_add_f32 v67, 0x42580000, v5
s_add_u32 m0, s56, 74496
v_mul_f32 v60, v4, v60
buffer_load_dwordx4 v34, s[28:31], 0 offen offset:256  lds
v_mul_f32 v61, v4, v61
v_mul_f32 v62, v4, v62
v_mul_f32 v63, v4, v63
v_mul_f32 v64, v4, v64
v_mul_f32 v65, v4, v65
v_mul_f32 v66, v4, v66
v_mul_f32 v67, v4, v67
v_fract_f32 v60, v60
v_fract_f32 v61, v61
v_fract_f32 v62, v62
v_fract_f32 v63, v63
v_fract_f32 v64, v64
v_fract_f32 v65, v65
v_fract_f32 v66, v66
v_fract_f32 v67, v67
v_cos_f32 v68, v60
v_cos_f32 v69, v61
v_cos_f32 v70, v62
v_cos_f32 v71, v63
s_add_u32 m0, s56, 75520
v_cos_f32 v72, v64
buffer_load_dwordx4 v35, s[28:31], 0 offen offset:256  lds
v_cos_f32 v73, v65
v_cos_f32 v74, v66
v_cos_f32 v75, v67
v_sin_f32 v76, v60
v_sin_f32 v77, v61
v_sin_f32 v78, v62
v_sin_f32 v79, v63
v_sin_f32 v80, v64
v_sin_f32 v81, v65
v_sin_f32 v82, v66
v_sin_f32 v83, v67
v_cvt_pk_bf16_f32 v216, v68, v69
v_cvt_pk_bf16_f32 v217, v70, v71
v_cvt_pk_bf16_f32 v218, v76, v77
v_cvt_pk_bf16_f32 v219, v78, v79
v_mov_b32 v232, v216
v_mov_b32 v233, v217
v_xor_b32 v234, s18, v218
v_xor_b32 v235, s18, v219
v_xor_b32 v218, s17, v218
v_xor_b32 v219, s17, v219
v_cvt_pk_bf16_f32 v220, v72, v73
v_cvt_pk_bf16_f32 v221, v74, v75
v_cvt_pk_bf16_f32 v222, v80, v81
v_cvt_pk_bf16_f32 v223, v82, v83
v_mov_b32 v236, v220
v_mov_b32 v237, v221
v_xor_b32 v238, s18, v222
v_xor_b32 v239, s18, v223
v_xor_b32 v222, s17, v222
v_xor_b32 v223, s17, v223
s_waitcnt vmcnt(18)
s_barrier
ds_read_b128 v[36:39], v18 offset:0
ds_read_b128 v[40:43], v18 offset:2048
ds_read_b128 v[44:47], v18 offset:4096
ds_read_b64_tr_b16 v[48:49], v16 offset:0
ds_read_b64_tr_b16 v[50:51], v16 offset:2048
ds_read_b64_tr_b16 v[52:53], v17 offset:0
ds_read_b64_tr_b16 v[54:55], v17 offset:2048
ds_read_b64_tr_b16 v[56:57], v16 offset:4096
ds_read_b64_tr_b16 v[58:59], v16 offset:6144
ds_read_b64_tr_b16 v[60:61], v17 offset:4096
ds_read_b64_tr_b16 v[62:63], v17 offset:6144
ds_read_b64_tr_b16 v[64:65], v16 offset:8192
ds_read_b64_tr_b16 v[66:67], v16 offset:10240
ds_read_b64_tr_b16 v[68:69], v17 offset:8192
ds_read_b64_tr_b16 v[70:71], v17 offset:10240
s_add_u32 m0, s55, 110592
s_mov_b32 s60, 516096
s_waitcnt lgkmcnt(8)
v_mfma_f32_16x16x32_bf16 v[108:111], v[48:51], v[36:39], 0
buffer_load_dwordx4 v32, s[32:35], s60 offen offset:0  lds
v_mfma_f32_16x16x32_bf16 v[116:119], v[48:51], v[40:43], 0
ds_read_b128 v[72:75], v19 offset:0
ds_read_b128 v[76:79], v19 offset:2048
v_mfma_f32_16x16x32_bf16 v[124:127], v[48:51], v[44:47], 0
ds_read_b128 v[80:83], v19 offset:4096
v_mfma_f32_16x16x32_bf16 v[112:115], v[52:55], v[36:39], 0
ds_read_b64_tr_b16 v[84:85], v16 offset:12288
s_add_u32 m0, s55, 113792
v_mfma_f32_16x16x32_bf16 v[120:123], v[52:55], v[40:43], 0
buffer_load_dwordx4 v32, s[32:35], s60 offen offset:896  lds
v_mfma_f32_16x16x32_bf16 v[128:131], v[52:55], v[44:47], 0
ds_read_b64_tr_b16 v[86:87], v16 offset:14336
ds_read_b64_tr_b16 v[88:89], v17 offset:12288
s_waitcnt lgkmcnt(10)
v_mfma_f32_16x16x32_bf16 v[132:135], v[56:59], v[36:39], 0
ds_read_b64_tr_b16 v[90:91], v17 offset:14336
v_mfma_f32_16x16x32_bf16 v[140:143], v[56:59], v[40:43], 0
ds_read_b64_tr_b16 v[92:93], v16 offset:16384
s_add_u32 m0, s55, 116992
v_mfma_f32_16x16x32_bf16 v[148:151], v[56:59], v[44:47], 0
buffer_load_dwordx4 v32, s[32:35], s60 offen offset:1792  lds
v_mfma_f32_16x16x32_bf16 v[136:139], v[60:63], v[36:39], 0
ds_read_b64_tr_b16 v[94:95], v16 offset:18432
ds_read_b64_tr_b16 v[96:97], v17 offset:16384
v_mfma_f32_16x16x32_bf16 v[144:147], v[60:63], v[40:43], 0
ds_read_b64_tr_b16 v[98:99], v17 offset:18432
v_mfma_f32_16x16x32_bf16 v[152:155], v[60:63], v[44:47], 0
ds_read_b64_tr_b16 v[100:101], v16 offset:20480
s_add_u32 m0, s55, 111616
s_mov_b32 s60, 559104
s_waitcnt lgkmcnt(12)
v_mfma_f32_16x16x32_bf16 v[156:159], v[36:39], v[64:67], 0
buffer_load_dwordx4 v32, s[32:35], s60 offen offset:0  lds
v_mfma_f32_16x16x32_bf16 v[164:167], v[40:43], v[64:67], 0
ds_read_b64_tr_b16 v[102:103], v16 offset:22528
ds_read_b64_tr_b16 v[104:105], v17 offset:20480
v_mfma_f32_16x16x32_bf16 v[172:175], v[44:47], v[64:67], 0
ds_read_b64_tr_b16 v[106:107], v17 offset:22528
v_mfma_f32_16x16x32_bf16 v[160:163], v[36:39], v[68:71], 0
s_add_u32 m0, s55, 114816
v_mfma_f32_16x16x32_bf16 v[168:171], v[40:43], v[68:71], 0
buffer_load_dwordx4 v32, s[32:35], s60 offen offset:896  lds
v_mfma_f32_16x16x32_bf16 v[176:179], v[44:47], v[68:71], 0
s_waitcnt lgkmcnt(8)
v_mfma_f32_16x16x32_bf16 v[108:111], v[84:87], v[72:75], v[108:111]
v_mfma_f32_16x16x32_bf16 v[116:119], v[84:87], v[76:79], v[116:119]
s_add_u32 m0, s55, 118016
v_mfma_f32_16x16x32_bf16 v[124:127], v[84:87], v[80:83], v[124:127]
buffer_load_dwordx4 v32, s[32:35], s60 offen offset:1792  lds
v_mfma_f32_16x16x32_bf16 v[112:115], v[88:91], v[72:75], v[112:115]
v_mfma_f32_16x16x32_bf16 v[120:123], v[88:91], v[76:79], v[120:123]
v_mfma_f32_16x16x32_bf16 v[128:131], v[88:91], v[80:83], v[128:131]
s_waitcnt lgkmcnt(0)
s_waitcnt vmcnt(15)
s_barrier
s_add_u32 m0, s56, 110208
v_mfma_f32_16x16x32_bf16 v[132:135], v[92:95], v[72:75], v[132:135]
buffer_load_dwordx4 v33, s[28:31], 0 offen offset:384  lds
v_mfma_f32_16x16x32_bf16 v[140:143], v[92:95], v[76:79], v[140:143]
ds_read_b128 v[36:39], v22 offset:0
ds_read_b128 v[40:43], v22 offset:2048
v_mfma_f32_16x16x32_bf16 v[148:151], v[92:95], v[80:83], v[148:151]
ds_read_b128 v[44:47], v22 offset:4096
ds_read_b64_tr_b16 v[48:49], v20 offset:0
v_mfma_f32_16x16x32_bf16 v[136:139], v[96:99], v[72:75], v[136:139]
ds_read_b64_tr_b16 v[50:51], v20 offset:2048
ds_read_b64_tr_b16 v[52:53], v21 offset:0
s_add_u32 m0, s56, 111232
v_mfma_f32_16x16x32_bf16 v[144:147], v[96:99], v[76:79], v[144:147]
buffer_load_dwordx4 v34, s[28:31], 0 offen offset:384  lds
v_mfma_f32_16x16x32_bf16 v[152:155], v[96:99], v[80:83], v[152:155]
ds_read_b64_tr_b16 v[54:55], v21 offset:2048
ds_read_b64_tr_b16 v[56:57], v20 offset:4096
v_mfma_f32_16x16x32_bf16 v[156:159], v[72:75], v[100:103], v[156:159]
ds_read_b64_tr_b16 v[58:59], v20 offset:6144
ds_read_b64_tr_b16 v[60:61], v21 offset:4096
v_mfma_f32_16x16x32_bf16 v[164:167], v[76:79], v[100:103], v[164:167]
ds_read_b64_tr_b16 v[62:63], v21 offset:6144
ds_read_b64_tr_b16 v[64:65], v20 offset:8192
s_add_u32 m0, s56, 112256
v_mfma_f32_16x16x32_bf16 v[172:175], v[80:83], v[100:103], v[172:175]
buffer_load_dwordx4 v35, s[28:31], 0 offen offset:384  lds
v_mfma_f32_16x16x32_bf16 v[160:163], v[72:75], v[104:107], v[160:163]
ds_read_b64_tr_b16 v[66:67], v20 offset:10240
ds_read_b64_tr_b16 v[68:69], v21 offset:8192
v_mfma_f32_16x16x32_bf16 v[168:171], v[76:79], v[104:107], v[168:171]
ds_read_b64_tr_b16 v[70:71], v21 offset:10240
v_mfma_f32_16x16x32_bf16 v[176:179], v[80:83], v[104:107], v[176:179]
s_add_u32 m0, s55, 0
s_mov_b32 s60, 688128
s_waitcnt lgkmcnt(8)
v_mfma_f32_16x16x32_bf16 v[108:111], v[48:51], v[36:39], v[108:111]
buffer_load_dwordx4 v32, s[32:35], s60 offen offset:0  lds
v_mfma_f32_16x16x32_bf16 v[116:119], v[48:51], v[40:43], v[116:119]
ds_read_b128 v[72:75], v23 offset:0
ds_read_b128 v[76:79], v23 offset:2048
v_mfma_f32_16x16x32_bf16 v[124:127], v[48:51], v[44:47], v[124:127]
ds_read_b128 v[80:83], v23 offset:4096
v_mfma_f32_16x16x32_bf16 v[112:115], v[52:55], v[36:39], v[112:115]
ds_read_b64_tr_b16 v[84:85], v20 offset:12288
s_add_u32 m0, s55, 3200
v_mfma_f32_16x16x32_bf16 v[120:123], v[52:55], v[40:43], v[120:123]
buffer_load_dwordx4 v32, s[32:35], s60 offen offset:896  lds
v_mfma_f32_16x16x32_bf16 v[128:131], v[52:55], v[44:47], v[128:131]
ds_read_b64_tr_b16 v[86:87], v20 offset:14336
ds_read_b64_tr_b16 v[88:89], v21 offset:12288
s_waitcnt lgkmcnt(10)
v_mfma_f32_16x16x32_bf16 v[132:135], v[56:59], v[36:39], v[132:135]
ds_read_b64_tr_b16 v[90:91], v21 offset:14336
v_mfma_f32_16x16x32_bf16 v[140:143], v[56:59], v[40:43], v[140:143]
ds_read_b64_tr_b16 v[92:93], v20 offset:16384
s_add_u32 m0, s55, 6400
v_mfma_f32_16x16x32_bf16 v[148:151], v[56:59], v[44:47], v[148:151]
buffer_load_dwordx4 v32, s[32:35], s60 offen offset:1792  lds
v_mfma_f32_16x16x32_bf16 v[136:139], v[60:63], v[36:39], v[136:139]
ds_read_b64_tr_b16 v[94:95], v20 offset:18432
ds_read_b64_tr_b16 v[96:97], v21 offset:16384
v_mfma_f32_16x16x32_bf16 v[144:147], v[60:63], v[40:43], v[144:147]
ds_read_b64_tr_b16 v[98:99], v21 offset:18432
v_mfma_f32_16x16x32_bf16 v[152:155], v[60:63], v[44:47], v[152:155]
ds_read_b64_tr_b16 v[100:101], v20 offset:20480
s_add_u32 m0, s55, 1024
s_mov_b32 s60, 731136
s_waitcnt lgkmcnt(12)
v_mfma_f32_16x16x32_bf16 v[156:159], v[36:39], v[64:67], v[156:159]
buffer_load_dwordx4 v32, s[32:35], s60 offen offset:0  lds
v_mfma_f32_16x16x32_bf16 v[164:167], v[40:43], v[64:67], v[164:167]
ds_read_b64_tr_b16 v[102:103], v20 offset:22528
ds_read_b64_tr_b16 v[104:105], v21 offset:20480
v_mfma_f32_16x16x32_bf16 v[172:175], v[44:47], v[64:67], v[172:175]
ds_read_b64_tr_b16 v[106:107], v21 offset:22528
v_mfma_f32_16x16x32_bf16 v[160:163], v[36:39], v[68:71], v[160:163]
s_add_u32 m0, s55, 4224
v_mfma_f32_16x16x32_bf16 v[168:171], v[40:43], v[68:71], v[168:171]
buffer_load_dwordx4 v32, s[32:35], s60 offen offset:896  lds
v_mfma_f32_16x16x32_bf16 v[176:179], v[44:47], v[68:71], v[176:179]
s_waitcnt lgkmcnt(8)
v_mfma_f32_16x16x32_bf16 v[108:111], v[84:87], v[72:75], v[108:111]
v_mfma_f32_16x16x32_bf16 v[116:119], v[84:87], v[76:79], v[116:119]
s_add_u32 m0, s55, 7424
v_mfma_f32_16x16x32_bf16 v[124:127], v[84:87], v[80:83], v[124:127]
buffer_load_dwordx4 v32, s[32:35], s60 offen offset:1792  lds
v_mfma_f32_16x16x32_bf16 v[112:115], v[88:91], v[72:75], v[112:115]
v_mfma_f32_16x16x32_bf16 v[120:123], v[88:91], v[76:79], v[120:123]
v_mfma_f32_16x16x32_bf16 v[128:131], v[88:91], v[80:83], v[128:131]
s_waitcnt lgkmcnt(0)
s_waitcnt vmcnt(15)
s_barrier
s_add_u32 m0, s56, -512
v_mfma_f32_16x16x32_bf16 v[132:135], v[92:95], v[72:75], v[132:135]
buffer_load_dwordx4 v33, s[28:31], 0 offen offset:512  lds
v_mfma_f32_16x16x32_bf16 v[140:143], v[92:95], v[76:79], v[140:143]
ds_read_b128 v[36:39], v26 offset:0
ds_read_b128 v[40:43], v26 offset:2048
v_mfma_f32_16x16x32_bf16 v[148:151], v[92:95], v[80:83], v[148:151]
ds_read_b128 v[44:47], v26 offset:4096
ds_read_b64_tr_b16 v[48:49], v24 offset:0
v_mfma_f32_16x16x32_bf16 v[136:139], v[96:99], v[72:75], v[136:139]
ds_read_b64_tr_b16 v[50:51], v24 offset:2048
ds_read_b64_tr_b16 v[52:53], v25 offset:0
s_add_u32 m0, s56, 512
v_mfma_f32_16x16x32_bf16 v[144:147], v[96:99], v[76:79], v[144:147]
buffer_load_dwordx4 v34, s[28:31], 0 offen offset:512  lds
v_mfma_f32_16x16x32_bf16 v[152:155], v[96:99], v[80:83], v[152:155]
ds_read_b64_tr_b16 v[54:55], v25 offset:2048
ds_read_b64_tr_b16 v[56:57], v24 offset:4096
v_mfma_f32_16x16x32_bf16 v[156:159], v[72:75], v[100:103], v[156:159]
ds_read_b64_tr_b16 v[58:59], v24 offset:6144
ds_read_b64_tr_b16 v[60:61], v25 offset:4096
v_mfma_f32_16x16x32_bf16 v[164:167], v[76:79], v[100:103], v[164:167]
ds_read_b64_tr_b16 v[62:63], v25 offset:6144
ds_read_b64_tr_b16 v[64:65], v24 offset:8192
s_add_u32 m0, s56, 1536
v_mfma_f32_16x16x32_bf16 v[172:175], v[80:83], v[100:103], v[172:175]
buffer_load_dwordx4 v35, s[28:31], 0 offen offset:512  lds
v_mfma_f32_16x16x32_bf16 v[160:163], v[72:75], v[104:107], v[160:163]
ds_read_b64_tr_b16 v[66:67], v24 offset:10240
ds_read_b64_tr_b16 v[68:69], v25 offset:8192
v_mfma_f32_16x16x32_bf16 v[168:171], v[76:79], v[104:107], v[168:171]
ds_read_b64_tr_b16 v[70:71], v25 offset:10240
v_mfma_f32_16x16x32_bf16 v[176:179], v[80:83], v[104:107], v[176:179]
s_add_u32 m0, s55, 36864
s_mov_b32 s60, 860160
s_waitcnt lgkmcnt(8)
v_mfma_f32_16x16x32_bf16 v[108:111], v[48:51], v[36:39], v[108:111]
buffer_load_dwordx4 v32, s[32:35], s60 offen offset:0  lds
v_mfma_f32_16x16x32_bf16 v[116:119], v[48:51], v[40:43], v[116:119]
ds_read_b128 v[72:75], v27 offset:0
ds_read_b128 v[76:79], v27 offset:2048
v_mfma_f32_16x16x32_bf16 v[124:127], v[48:51], v[44:47], v[124:127]
ds_read_b128 v[80:83], v27 offset:4096
v_mfma_f32_16x16x32_bf16 v[112:115], v[52:55], v[36:39], v[112:115]
ds_read_b64_tr_b16 v[84:85], v24 offset:12288
s_add_u32 m0, s55, 40064
v_mfma_f32_16x16x32_bf16 v[120:123], v[52:55], v[40:43], v[120:123]
buffer_load_dwordx4 v32, s[32:35], s60 offen offset:896  lds
v_mfma_f32_16x16x32_bf16 v[128:131], v[52:55], v[44:47], v[128:131]
ds_read_b64_tr_b16 v[86:87], v24 offset:14336
ds_read_b64_tr_b16 v[88:89], v25 offset:12288
s_waitcnt lgkmcnt(10)
v_mfma_f32_16x16x32_bf16 v[132:135], v[56:59], v[36:39], v[132:135]
ds_read_b64_tr_b16 v[90:91], v25 offset:14336
v_mfma_f32_16x16x32_bf16 v[140:143], v[56:59], v[40:43], v[140:143]
ds_read_b64_tr_b16 v[92:93], v24 offset:16384
s_add_u32 m0, s55, 43264
v_mfma_f32_16x16x32_bf16 v[148:151], v[56:59], v[44:47], v[148:151]
buffer_load_dwordx4 v32, s[32:35], s60 offen offset:1792  lds
v_mfma_f32_16x16x32_bf16 v[136:139], v[60:63], v[36:39], v[136:139]
ds_read_b64_tr_b16 v[94:95], v24 offset:18432
ds_read_b64_tr_b16 v[96:97], v25 offset:16384
v_mfma_f32_16x16x32_bf16 v[144:147], v[60:63], v[40:43], v[144:147]
ds_read_b64_tr_b16 v[98:99], v25 offset:18432
v_mfma_f32_16x16x32_bf16 v[152:155], v[60:63], v[44:47], v[152:155]
ds_read_b64_tr_b16 v[100:101], v24 offset:20480
s_add_u32 m0, s55, 37888
s_mov_b32 s60, 903168
s_waitcnt lgkmcnt(12)
v_mfma_f32_16x16x32_bf16 v[156:159], v[36:39], v[64:67], v[156:159]
buffer_load_dwordx4 v32, s[32:35], s60 offen offset:0  lds
v_mfma_f32_16x16x32_bf16 v[164:167], v[40:43], v[64:67], v[164:167]
ds_read_b64_tr_b16 v[102:103], v24 offset:22528
ds_read_b64_tr_b16 v[104:105], v25 offset:20480
v_mfma_f32_16x16x32_bf16 v[172:175], v[44:47], v[64:67], v[172:175]
ds_read_b64_tr_b16 v[106:107], v25 offset:22528
v_mfma_f32_16x16x32_bf16 v[160:163], v[36:39], v[68:71], v[160:163]
s_add_u32 m0, s55, 41088
v_mfma_f32_16x16x32_bf16 v[168:171], v[40:43], v[68:71], v[168:171]
buffer_load_dwordx4 v32, s[32:35], s60 offen offset:896  lds
v_mfma_f32_16x16x32_bf16 v[176:179], v[44:47], v[68:71], v[176:179]
s_waitcnt lgkmcnt(8)
v_mfma_f32_16x16x32_bf16 v[108:111], v[84:87], v[72:75], v[108:111]
v_mfma_f32_16x16x32_bf16 v[116:119], v[84:87], v[76:79], v[116:119]
s_add_u32 m0, s55, 44288
v_mfma_f32_16x16x32_bf16 v[124:127], v[84:87], v[80:83], v[124:127]
buffer_load_dwordx4 v32, s[32:35], s60 offen offset:1792  lds
v_mfma_f32_16x16x32_bf16 v[112:115], v[88:91], v[72:75], v[112:115]
v_mfma_f32_16x16x32_bf16 v[120:123], v[88:91], v[76:79], v[120:123]
v_mfma_f32_16x16x32_bf16 v[128:131], v[88:91], v[80:83], v[128:131]
s_waitcnt lgkmcnt(0)
s_waitcnt vmcnt(15)
s_barrier
s_add_u32 m0, s56, 36224
v_mfma_f32_16x16x32_bf16 v[132:135], v[92:95], v[72:75], v[132:135]
buffer_load_dwordx4 v33, s[28:31], 0 offen offset:640  lds
v_mfma_f32_16x16x32_bf16 v[140:143], v[92:95], v[76:79], v[140:143]
ds_read_b128 v[36:39], v30 offset:0
ds_read_b128 v[40:43], v30 offset:2048
v_mfma_f32_16x16x32_bf16 v[148:151], v[92:95], v[80:83], v[148:151]
ds_read_b128 v[44:47], v30 offset:4096
ds_read_b64_tr_b16 v[48:49], v28 offset:0
v_mfma_f32_16x16x32_bf16 v[136:139], v[96:99], v[72:75], v[136:139]
ds_read_b64_tr_b16 v[50:51], v28 offset:2048
ds_read_b64_tr_b16 v[52:53], v29 offset:0
s_add_u32 m0, s56, 37248
v_mfma_f32_16x16x32_bf16 v[144:147], v[96:99], v[76:79], v[144:147]
buffer_load_dwordx4 v34, s[28:31], 0 offen offset:640  lds
v_mfma_f32_16x16x32_bf16 v[152:155], v[96:99], v[80:83], v[152:155]
ds_read_b64_tr_b16 v[54:55], v29 offset:2048
ds_read_b64_tr_b16 v[56:57], v28 offset:4096
v_mfma_f32_16x16x32_bf16 v[156:159], v[72:75], v[100:103], v[156:159]
ds_read_b64_tr_b16 v[58:59], v28 offset:6144
ds_read_b64_tr_b16 v[60:61], v29 offset:4096
v_mfma_f32_16x16x32_bf16 v[164:167], v[76:79], v[100:103], v[164:167]
ds_read_b64_tr_b16 v[62:63], v29 offset:6144
ds_read_b64_tr_b16 v[64:65], v28 offset:8192
s_add_u32 m0, s56, 38272
v_mfma_f32_16x16x32_bf16 v[172:175], v[80:83], v[100:103], v[172:175]
buffer_load_dwordx4 v35, s[28:31], 0 offen offset:640  lds
v_mfma_f32_16x16x32_bf16 v[160:163], v[72:75], v[104:107], v[160:163]
ds_read_b64_tr_b16 v[66:67], v28 offset:10240
ds_read_b64_tr_b16 v[68:69], v29 offset:8192
v_mfma_f32_16x16x32_bf16 v[168:171], v[76:79], v[104:107], v[168:171]
ds_read_b64_tr_b16 v[70:71], v29 offset:10240
v_mfma_f32_16x16x32_bf16 v[176:179], v[80:83], v[104:107], v[176:179]
s_add_u32 m0, s55, 73728
s_mov_b32 s60, 1032192
s_waitcnt lgkmcnt(8)
v_mfma_f32_16x16x32_bf16 v[108:111], v[48:51], v[36:39], v[108:111]
buffer_load_dwordx4 v32, s[32:35], s60 offen offset:0  lds
v_mfma_f32_16x16x32_bf16 v[116:119], v[48:51], v[40:43], v[116:119]
ds_read_b128 v[72:75], v31 offset:0
ds_read_b128 v[76:79], v31 offset:2048
v_mfma_f32_16x16x32_bf16 v[124:127], v[48:51], v[44:47], v[124:127]
ds_read_b128 v[80:83], v31 offset:4096
v_mfma_f32_16x16x32_bf16 v[112:115], v[52:55], v[36:39], v[112:115]
ds_read_b64_tr_b16 v[84:85], v28 offset:12288
s_add_u32 m0, s55, 76928
v_mfma_f32_16x16x32_bf16 v[120:123], v[52:55], v[40:43], v[120:123]
buffer_load_dwordx4 v32, s[32:35], s60 offen offset:896  lds
v_mfma_f32_16x16x32_bf16 v[128:131], v[52:55], v[44:47], v[128:131]
ds_read_b64_tr_b16 v[86:87], v28 offset:14336
ds_read_b64_tr_b16 v[88:89], v29 offset:12288
s_waitcnt lgkmcnt(10)
v_mfma_f32_16x16x32_bf16 v[132:135], v[56:59], v[36:39], v[132:135]
ds_read_b64_tr_b16 v[90:91], v29 offset:14336
v_mfma_f32_16x16x32_bf16 v[140:143], v[56:59], v[40:43], v[140:143]
ds_read_b64_tr_b16 v[92:93], v28 offset:16384
s_add_u32 m0, s55, 80128
v_mfma_f32_16x16x32_bf16 v[148:151], v[56:59], v[44:47], v[148:151]
buffer_load_dwordx4 v32, s[32:35], s60 offen offset:1792  lds
v_mfma_f32_16x16x32_bf16 v[136:139], v[60:63], v[36:39], v[136:139]
ds_read_b64_tr_b16 v[94:95], v28 offset:18432
ds_read_b64_tr_b16 v[96:97], v29 offset:16384
v_mfma_f32_16x16x32_bf16 v[144:147], v[60:63], v[40:43], v[144:147]
ds_read_b64_tr_b16 v[98:99], v29 offset:18432
v_mfma_f32_16x16x32_bf16 v[152:155], v[60:63], v[44:47], v[152:155]
ds_read_b64_tr_b16 v[100:101], v28 offset:20480
s_add_u32 m0, s55, 74752
s_mov_b32 s60, 1075200
s_waitcnt lgkmcnt(12)
v_mfma_f32_16x16x32_bf16 v[156:159], v[36:39], v[64:67], v[156:159]
buffer_load_dwordx4 v32, s[32:35], s60 offen offset:0  lds
v_mfma_f32_16x16x32_bf16 v[164:167], v[40:43], v[64:67], v[164:167]
ds_read_b64_tr_b16 v[102:103], v28 offset:22528
ds_read_b64_tr_b16 v[104:105], v29 offset:20480
v_mfma_f32_16x16x32_bf16 v[172:175], v[44:47], v[64:67], v[172:175]
ds_read_b64_tr_b16 v[106:107], v29 offset:22528
v_mfma_f32_16x16x32_bf16 v[160:163], v[36:39], v[68:71], v[160:163]
s_add_u32 m0, s55, 77952
v_mfma_f32_16x16x32_bf16 v[168:171], v[40:43], v[68:71], v[168:171]
buffer_load_dwordx4 v32, s[32:35], s60 offen offset:896  lds
v_mfma_f32_16x16x32_bf16 v[176:179], v[44:47], v[68:71], v[176:179]
s_waitcnt lgkmcnt(8)
v_mfma_f32_16x16x32_bf16 v[108:111], v[84:87], v[72:75], v[108:111]
v_mfma_f32_16x16x32_bf16 v[116:119], v[84:87], v[76:79], v[116:119]
s_add_u32 m0, s55, 81152
v_mfma_f32_16x16x32_bf16 v[124:127], v[84:87], v[80:83], v[124:127]
buffer_load_dwordx4 v32, s[32:35], s60 offen offset:1792  lds
v_mfma_f32_16x16x32_bf16 v[112:115], v[88:91], v[72:75], v[112:115]
v_mfma_f32_16x16x32_bf16 v[120:123], v[88:91], v[76:79], v[120:123]
v_mfma_f32_16x16x32_bf16 v[128:131], v[88:91], v[80:83], v[128:131]
s_waitcnt lgkmcnt(0)
s_waitcnt vmcnt(15)
s_barrier
s_add_u32 m0, s56, 72960
v_mfma_f32_16x16x32_bf16 v[132:135], v[92:95], v[72:75], v[132:135]
buffer_load_dwordx4 v33, s[28:31], 0 offen offset:768  lds
v_mfma_f32_16x16x32_bf16 v[140:143], v[92:95], v[76:79], v[140:143]
ds_read_b128 v[36:39], v18 offset:0
ds_read_b128 v[40:43], v18 offset:2048
v_mfma_f32_16x16x32_bf16 v[148:151], v[92:95], v[80:83], v[148:151]
ds_read_b128 v[44:47], v18 offset:4096
ds_read_b64_tr_b16 v[48:49], v16 offset:0
v_mfma_f32_16x16x32_bf16 v[136:139], v[96:99], v[72:75], v[136:139]
ds_read_b64_tr_b16 v[50:51], v16 offset:2048
ds_read_b64_tr_b16 v[52:53], v17 offset:0
s_add_u32 m0, s56, 73984
v_mfma_f32_16x16x32_bf16 v[144:147], v[96:99], v[76:79], v[144:147]
buffer_load_dwordx4 v34, s[28:31], 0 offen offset:768  lds
v_mfma_f32_16x16x32_bf16 v[152:155], v[96:99], v[80:83], v[152:155]
ds_read_b64_tr_b16 v[54:55], v17 offset:2048
ds_read_b64_tr_b16 v[56:57], v16 offset:4096
v_mfma_f32_16x16x32_bf16 v[156:159], v[72:75], v[100:103], v[156:159]
ds_read_b64_tr_b16 v[58:59], v16 offset:6144
ds_read_b64_tr_b16 v[60:61], v17 offset:4096
v_mfma_f32_16x16x32_bf16 v[164:167], v[76:79], v[100:103], v[164:167]
ds_read_b64_tr_b16 v[62:63], v17 offset:6144
ds_read_b64_tr_b16 v[64:65], v16 offset:8192
s_add_u32 m0, s56, 75008
v_mfma_f32_16x16x32_bf16 v[172:175], v[80:83], v[100:103], v[172:175]
buffer_load_dwordx4 v35, s[28:31], 0 offen offset:768  lds
v_mfma_f32_16x16x32_bf16 v[160:163], v[72:75], v[104:107], v[160:163]
ds_read_b64_tr_b16 v[66:67], v16 offset:10240
ds_read_b64_tr_b16 v[68:69], v17 offset:8192
v_mfma_f32_16x16x32_bf16 v[168:171], v[76:79], v[104:107], v[168:171]
ds_read_b64_tr_b16 v[70:71], v17 offset:10240
v_mfma_f32_16x16x32_bf16 v[176:179], v[80:83], v[104:107], v[176:179]
s_waitcnt lgkmcnt(8)
v_mfma_f32_16x16x32_bf16 v[108:111], v[48:51], v[36:39], v[108:111]
buffer_load_dword v205, off, s[24:27], 0 sc1
v_mfma_f32_16x16x32_bf16 v[116:119], v[48:51], v[40:43], v[116:119]
ds_read_b128 v[72:75], v19 offset:0
ds_read_b128 v[76:79], v19 offset:2048
v_mfma_f32_16x16x32_bf16 v[124:127], v[48:51], v[44:47], v[124:127]
ds_read_b128 v[80:83], v19 offset:4096
v_mfma_f32_16x16x32_bf16 v[112:115], v[52:55], v[36:39], v[112:115]
ds_read_b64_tr_b16 v[84:85], v16 offset:12288
s_add_u32 m0, s100, 110592
s_mov_b32 s89, 0
v_mfma_f32_16x16x32_bf16 v[120:123], v[52:55], v[40:43], v[120:123]
buffer_load_dwordx4 v204, s[96:99], s89 offen lds
v_mfma_f32_16x16x32_bf16 v[128:131], v[52:55], v[44:47], v[128:131]
ds_read_b64_tr_b16 v[86:87], v16 offset:14336
ds_read_b64_tr_b16 v[88:89], v17 offset:12288
s_waitcnt lgkmcnt(10)
v_mfma_f32_16x16x32_bf16 v[132:135], v[56:59], v[36:39], v[132:135]
ds_read_b64_tr_b16 v[90:91], v17 offset:14336
v_mfma_f32_16x16x32_bf16 v[140:143], v[56:59], v[40:43], v[140:143]
ds_read_b64_tr_b16 v[92:93], v16 offset:16384
s_add_u32 m0, s100, 114688
s_mov_b32 s89, 28672
v_mfma_f32_16x16x32_bf16 v[148:151], v[56:59], v[44:47], v[148:151]
buffer_load_dwordx4 v204, s[96:99], s89 offen lds
v_mfma_f32_16x16x32_bf16 v[136:139], v[60:63], v[36:39], v[136:139]
ds_read_b64_tr_b16 v[94:95], v16 offset:18432
ds_read_b64_tr_b16 v[96:97], v17 offset:16384
v_mfma_f32_16x16x32_bf16 v[144:147], v[60:63], v[40:43], v[144:147]
ds_read_b64_tr_b16 v[98:99], v17 offset:18432
v_mfma_f32_16x16x32_bf16 v[152:155], v[60:63], v[44:47], v[152:155]
ds_read_b64_tr_b16 v[100:101], v16 offset:20480
s_add_u32 m0, s100, 118784
s_mov_b32 s89, 57344
s_waitcnt lgkmcnt(12)
v_mfma_f32_16x16x32_bf16 v[156:159], v[36:39], v[64:67], v[156:159]
buffer_load_dwordx4 v204, s[96:99], s89 offen lds
v_mfma_f32_16x16x32_bf16 v[164:167], v[40:43], v[64:67], v[164:167]
ds_read_b64_tr_b16 v[102:103], v16 offset:22528
ds_read_b64_tr_b16 v[104:105], v17 offset:20480
v_mfma_f32_16x16x32_bf16 v[172:175], v[44:47], v[64:67], v[172:175]
ds_read_b64_tr_b16 v[106:107], v17 offset:22528
v_mfma_f32_16x16x32_bf16 v[160:163], v[36:39], v[68:71], v[160:163]
s_add_u32 m0, s100, 122880
s_mov_b32 s89, 86016
v_mfma_f32_16x16x32_bf16 v[168:171], v[40:43], v[68:71], v[168:171]
buffer_load_dwordx4 v204, s[96:99], s89 offen lds
v_mfma_f32_16x16x32_bf16 v[176:179], v[44:47], v[68:71], v[176:179]
s_waitcnt lgkmcnt(8)
v_mfma_f32_16x16x32_bf16 v[108:111], v[84:87], v[72:75], v[108:111]
v_mfma_f32_16x16x32_bf16 v[116:119], v[84:87], v[76:79], v[116:119]
s_add_u32 m0, s100, 126976
s_mov_b32 s89, 114688
v_mfma_f32_16x16x32_bf16 v[124:127], v[84:87], v[80:83], v[124:127]
buffer_load_dwordx4 v204, s[96:99], s89 offen lds
v_mfma_f32_16x16x32_bf16 v[112:115], v[88:91], v[72:75], v[112:115]
v_mfma_f32_16x16x32_bf16 v[120:123], v[88:91], v[76:79], v[120:123]
v_mfma_f32_16x16x32_bf16 v[128:131], v[88:91], v[80:83], v[128:131]
s_waitcnt lgkmcnt(0)
s_waitcnt vmcnt(15)
s_barrier
s_add_u32 m0, s100, 131072
s_mov_b32 s89, 143360
v_mfma_f32_16x16x32_bf16 v[132:135], v[92:95], v[72:75], v[132:135]
buffer_load_dwordx4 v204, s[96:99], s89 offen lds
v_mfma_f32_16x16x32_bf16 v[140:143], v[92:95], v[76:79], v[140:143]
ds_read_b128 v[36:39], v22 offset:0
ds_read_b128 v[40:43], v22 offset:2048
v_mfma_f32_16x16x32_bf16 v[148:151], v[92:95], v[80:83], v[148:151]
ds_read_b128 v[44:47], v22 offset:4096
ds_read_b64_tr_b16 v[48:49], v20 offset:0
v_mfma_f32_16x16x32_bf16 v[136:139], v[96:99], v[72:75], v[136:139]
ds_read_b64_tr_b16 v[50:51], v20 offset:2048
ds_read_b64_tr_b16 v[52:53], v21 offset:0
s_add_u32 m0, s100, 135168
s_mov_b32 s89, 172032
v_mfma_f32_16x16x32_bf16 v[144:147], v[96:99], v[76:79], v[144:147]
buffer_load_dwordx4 v204, s[96:99], s89 offen lds
v_mfma_f32_16x16x32_bf16 v[152:155], v[96:99], v[80:83], v[152:155]
ds_read_b64_tr_b16 v[54:55], v21 offset:2048
ds_read_b64_tr_b16 v[56:57], v20 offset:4096
v_mfma_f32_16x16x32_bf16 v[156:159], v[72:75], v[100:103], v[156:159]
ds_read_b64_tr_b16 v[58:59], v20 offset:6144
ds_read_b64_tr_b16 v[60:61], v21 offset:4096
v_mfma_f32_16x16x32_bf16 v[164:167], v[76:79], v[100:103], v[164:167]
ds_read_b64_tr_b16 v[62:63], v21 offset:6144
ds_read_b64_tr_b16 v[64:65], v20 offset:8192
s_add_u32 m0, s100, 139264
s_mov_b32 s89, 200704
v_mfma_f32_16x16x32_bf16 v[172:175], v[80:83], v[100:103], v[172:175]
buffer_load_dwordx4 v204, s[96:99], s89 offen lds
v_mfma_f32_16x16x32_bf16 v[160:163], v[72:75], v[104:107], v[160:163]
ds_read_b64_tr_b16 v[66:67], v20 offset:10240
ds_read_b64_tr_b16 v[68:69], v21 offset:8192
v_mfma_f32_16x16x32_bf16 v[168:171], v[76:79], v[104:107], v[168:171]
ds_read_b64_tr_b16 v[70:71], v21 offset:10240
v_mfma_f32_16x16x32_bf16 v[176:179], v[80:83], v[104:107], v[176:179]
s_add_u32 m0, s100, 0
s_mov_b32 s89, 200704
s_waitcnt lgkmcnt(8)
v_mfma_f32_16x16x32_bf16 v[108:111], v[48:51], v[36:39], v[108:111]
buffer_load_dwordx4 v204, s[96:99], s89 offen lds
v_mfma_f32_16x16x32_bf16 v[116:119], v[48:51], v[40:43], v[116:119]
ds_read_b128 v[72:75], v23 offset:0
ds_read_b128 v[76:79], v23 offset:2048
v_mfma_f32_16x16x32_bf16 v[124:127], v[48:51], v[44:47], v[124:127]
ds_read_b128 v[80:83], v23 offset:4096
v_mfma_f32_16x16x32_bf16 v[112:115], v[52:55], v[36:39], v[112:115]
ds_read_b64_tr_b16 v[84:85], v20 offset:12288
s_add_u32 m0, s100, 4096
s_mov_b32 s89, 229376
v_mfma_f32_16x16x32_bf16 v[120:123], v[52:55], v[40:43], v[120:123]
buffer_load_dwordx4 v204, s[96:99], s89 offen lds
v_mfma_f32_16x16x32_bf16 v[128:131], v[52:55], v[44:47], v[128:131]
ds_read_b64_tr_b16 v[86:87], v20 offset:14336
ds_read_b64_tr_b16 v[88:89], v21 offset:12288
s_waitcnt lgkmcnt(10)
v_mfma_f32_16x16x32_bf16 v[132:135], v[56:59], v[36:39], v[132:135]
ds_read_b64_tr_b16 v[90:91], v21 offset:14336
v_mfma_f32_16x16x32_bf16 v[140:143], v[56:59], v[40:43], v[140:143]
ds_read_b64_tr_b16 v[92:93], v20 offset:16384
s_add_u32 m0, s100, 8192
s_mov_b32 s89, 258048
v_mfma_f32_16x16x32_bf16 v[148:151], v[56:59], v[44:47], v[148:151]
buffer_load_dwordx4 v204, s[96:99], s89 offen lds
v_mfma_f32_16x16x32_bf16 v[136:139], v[60:63], v[36:39], v[136:139]
ds_read_b64_tr_b16 v[94:95], v20 offset:18432
ds_read_b64_tr_b16 v[96:97], v21 offset:16384
v_mfma_f32_16x16x32_bf16 v[144:147], v[60:63], v[40:43], v[144:147]
ds_read_b64_tr_b16 v[98:99], v21 offset:18432
v_mfma_f32_16x16x32_bf16 v[152:155], v[60:63], v[44:47], v[152:155]
ds_read_b64_tr_b16 v[100:101], v20 offset:20480
s_add_u32 m0, s100, 12288
s_mov_b32 s89, 286720
s_waitcnt lgkmcnt(12)
v_mfma_f32_16x16x32_bf16 v[156:159], v[36:39], v[64:67], v[156:159]
buffer_load_dwordx4 v204, s[96:99], s89 offen lds
v_mfma_f32_16x16x32_bf16 v[164:167], v[40:43], v[64:67], v[164:167]
ds_read_b64_tr_b16 v[102:103], v20 offset:22528
ds_read_b64_tr_b16 v[104:105], v21 offset:20480
v_mfma_f32_16x16x32_bf16 v[172:175], v[44:47], v[64:67], v[172:175]
ds_read_b64_tr_b16 v[106:107], v21 offset:22528
v_mfma_f32_16x16x32_bf16 v[160:163], v[36:39], v[68:71], v[160:163]
s_add_u32 m0, s100, 16384
s_mov_b32 s89, 315392
v_mfma_f32_16x16x32_bf16 v[168:171], v[40:43], v[68:71], v[168:171]
buffer_load_dwordx4 v204, s[96:99], s89 offen lds
v_mfma_f32_16x16x32_bf16 v[176:179], v[44:47], v[68:71], v[176:179]
s_waitcnt lgkmcnt(8)
v_mfma_f32_16x16x32_bf16 v[108:111], v[84:87], v[72:75], v[108:111]
v_mfma_f32_16x16x32_bf16 v[116:119], v[84:87], v[76:79], v[116:119]
s_add_u32 m0, s100, 20480
s_mov_b32 s89, 344064
v_mfma_f32_16x16x32_bf16 v[124:127], v[84:87], v[80:83], v[124:127]
buffer_load_dwordx4 v204, s[96:99], s89 offen lds
v_mfma_f32_16x16x32_bf16 v[112:115], v[88:91], v[72:75], v[112:115]
v_mfma_f32_16x16x32_bf16 v[120:123], v[88:91], v[76:79], v[120:123]
v_mfma_f32_16x16x32_bf16 v[128:131], v[88:91], v[80:83], v[128:131]
s_waitcnt lgkmcnt(0)
s_waitcnt vmcnt(15)
s_barrier
s_add_u32 m0, s100, 24576
s_mov_b32 s89, 372736
v_mfma_f32_16x16x32_bf16 v[132:135], v[92:95], v[72:75], v[132:135]
buffer_load_dwordx4 v204, s[96:99], s89 offen lds
v_mfma_f32_16x16x32_bf16 v[140:143], v[92:95], v[76:79], v[140:143]
ds_read_b128 v[36:39], v26 offset:0
ds_read_b128 v[40:43], v26 offset:2048
v_mfma_f32_16x16x32_bf16 v[148:151], v[92:95], v[80:83], v[148:151]
ds_read_b128 v[44:47], v26 offset:4096
ds_read_b64_tr_b16 v[48:49], v24 offset:0
v_mfma_f32_16x16x32_bf16 v[136:139], v[96:99], v[72:75], v[136:139]
ds_read_b64_tr_b16 v[50:51], v24 offset:2048
ds_read_b64_tr_b16 v[52:53], v25 offset:0
s_add_u32 m0, s100, 28672
s_mov_b32 s89, 401408
v_mfma_f32_16x16x32_bf16 v[144:147], v[96:99], v[76:79], v[144:147]
buffer_load_dwordx4 v204, s[96:99], s89 offen lds
v_mfma_f32_16x16x32_bf16 v[152:155], v[96:99], v[80:83], v[152:155]
ds_read_b64_tr_b16 v[54:55], v25 offset:2048
ds_read_b64_tr_b16 v[56:57], v24 offset:4096
v_mfma_f32_16x16x32_bf16 v[156:159], v[72:75], v[100:103], v[156:159]
ds_read_b64_tr_b16 v[58:59], v24 offset:6144
ds_read_b64_tr_b16 v[60:61], v25 offset:4096
v_mfma_f32_16x16x32_bf16 v[164:167], v[76:79], v[100:103], v[164:167]
ds_read_b64_tr_b16 v[62:63], v25 offset:6144
ds_read_b64_tr_b16 v[64:65], v24 offset:8192
v_mfma_f32_16x16x32_bf16 v[172:175], v[80:83], v[100:103], v[172:175]
ds_read_b64_tr_b16 v[66:67], v24 offset:10240
ds_read_b64_tr_b16 v[68:69], v25 offset:8192
v_mfma_f32_16x16x32_bf16 v[160:163], v[72:75], v[104:107], v[160:163]
ds_read_b64_tr_b16 v[70:71], v25 offset:10240
v_mfma_f32_16x16x32_bf16 v[168:171], v[76:79], v[104:107], v[168:171]
v_mfma_f32_16x16x32_bf16 v[176:179], v[80:83], v[104:107], v[176:179]
s_waitcnt lgkmcnt(8)
v_mfma_f32_16x16x32_bf16 v[108:111], v[48:51], v[36:39], v[108:111]
ds_read_b128 v[72:75], v27 offset:0
v_mfma_f32_16x16x32_bf16 v[116:119], v[48:51], v[40:43], v[116:119]
ds_read_b128 v[76:79], v27 offset:2048
v_mfma_f32_16x16x32_bf16 v[124:127], v[48:51], v[44:47], v[124:127]
ds_read_b128 v[80:83], v27 offset:4096
v_mfma_f32_16x16x32_bf16 v[112:115], v[52:55], v[36:39], v[112:115]
ds_read_b64_tr_b16 v[84:85], v24 offset:12288
v_mfma_f32_16x16x32_bf16 v[120:123], v[52:55], v[40:43], v[120:123]
ds_read_b64_tr_b16 v[86:87], v24 offset:14336
v_mfma_f32_16x16x32_bf16 v[128:131], v[52:55], v[44:47], v[128:131]
ds_read_b64_tr_b16 v[88:89], v25 offset:12288
s_waitcnt lgkmcnt(10)
v_mfma_f32_16x16x32_bf16 v[132:135], v[56:59], v[36:39], v[132:135]
ds_read_b64_tr_b16 v[90:91], v25 offset:14336
v_mfma_f32_16x16x32_bf16 v[140:143], v[56:59], v[40:43], v[140:143]
ds_read_b64_tr_b16 v[92:93], v24 offset:16384
v_mfma_f32_16x16x32_bf16 v[148:151], v[56:59], v[44:47], v[148:151]
ds_read_b64_tr_b16 v[94:95], v24 offset:18432
v_mfma_f32_16x16x32_bf16 v[136:139], v[60:63], v[36:39], v[136:139]
ds_read_b64_tr_b16 v[96:97], v25 offset:16384
v_mfma_f32_16x16x32_bf16 v[144:147], v[60:63], v[40:43], v[144:147]
ds_read_b64_tr_b16 v[98:99], v25 offset:18432
v_mfma_f32_16x16x32_bf16 v[152:155], v[60:63], v[44:47], v[152:155]
ds_read_b64_tr_b16 v[100:101], v24 offset:20480
s_waitcnt lgkmcnt(12)
v_mfma_f32_16x16x32_bf16 v[156:159], v[36:39], v[64:67], v[156:159]
ds_read_b64_tr_b16 v[102:103], v24 offset:22528
v_mfma_f32_16x16x32_bf16 v[164:167], v[40:43], v[64:67], v[164:167]
ds_read_b64_tr_b16 v[104:105], v25 offset:20480
v_mfma_f32_16x16x32_bf16 v[172:175], v[44:47], v[64:67], v[172:175]
ds_read_b64_tr_b16 v[106:107], v25 offset:22528
v_mfma_f32_16x16x32_bf16 v[160:163], v[36:39], v[68:71], v[160:163]
v_mfma_f32_16x16x32_bf16 v[168:171], v[40:43], v[68:71], v[168:171]
v_mfma_f32_16x16x32_bf16 v[176:179], v[44:47], v[68:71], v[176:179]
s_waitcnt lgkmcnt(8)
v_mfma_f32_16x16x32_bf16 v[108:111], v[84:87], v[72:75], v[108:111]
v_mfma_f32_16x16x32_bf16 v[116:119], v[84:87], v[76:79], v[116:119]
v_mfma_f32_16x16x32_bf16 v[124:127], v[84:87], v[80:83], v[124:127]
v_mfma_f32_16x16x32_bf16 v[112:115], v[88:91], v[72:75], v[112:115]
v_mfma_f32_16x16x32_bf16 v[120:123], v[88:91], v[76:79], v[120:123]
v_mfma_f32_16x16x32_bf16 v[128:131], v[88:91], v[80:83], v[128:131]
s_waitcnt lgkmcnt(4)
v_mfma_f32_16x16x32_bf16 v[132:135], v[92:95], v[72:75], v[132:135]
v_mfma_f32_16x16x32_bf16 v[140:143], v[92:95], v[76:79], v[140:143]
v_mfma_f32_16x16x32_bf16 v[148:151], v[92:95], v[80:83], v[148:151]
v_mfma_f32_16x16x32_bf16 v[136:139], v[96:99], v[72:75], v[136:139]
v_mfma_f32_16x16x32_bf16 v[144:147], v[96:99], v[76:79], v[144:147]
v_mfma_f32_16x16x32_bf16 v[152:155], v[96:99], v[80:83], v[152:155]
s_waitcnt lgkmcnt(0)
v_mfma_f32_16x16x32_bf16 v[156:159], v[72:75], v[100:103], v[156:159]
v_mfma_f32_16x16x32_bf16 v[164:167], v[76:79], v[100:103], v[164:167]
v_mfma_f32_16x16x32_bf16 v[172:175], v[80:83], v[100:103], v[172:175]
v_mfma_f32_16x16x32_bf16 v[160:163], v[72:75], v[104:107], v[160:163]
v_mfma_f32_16x16x32_bf16 v[168:171], v[76:79], v[104:107], v[168:171]
v_mfma_f32_16x16x32_bf16 v[176:179], v[80:83], v[104:107], v[176:179]
s_mov_b32 s56, 0x0
s_mov_b32 s64, 0xff000ff
s_mov_b32 s57, 0xf0000
s_mov_b32 s65, 0xf000ff00
s_mov_b32 s58, 0x0
s_mov_b32 s66, 0x1fe001fe
s_mov_b32 s59, 0x1f0001
s_mov_b32 s67, 0xe000fe00
s_mov_b32 s60, 0x0
s_mov_b32 s68, 0x3fc003fc
s_mov_b32 s61, 0x3f0003
s_mov_b32 s69, 0xc000fc00
s_mov_b32 s62, 0x0
s_mov_b32 s70, 0x7f8007f8
s_mov_b32 s63, 0x7f0007
s_mov_b32 s71, 0x8000f800
v_cvt_pk_bf16_f32 v60, v148, v149
v_cvt_pk_bf16_f32 v61, v150, v151
v_cvt_pk_bf16_f32 v62, v152, v153
v_cvt_pk_bf16_f32 v63, v154, v155
v_lshlrev_b32 v2, 4, v1
s_lshl_b32 s52, s44, 11
s_add_u32 s52, s52, 147456
v_add_u32 v3, s52, v2
s_lshl_b32 s52, s51, 11
s_add_u32 s52, s52, 147456
v_add_u32 v4, s52, v2
v_cvt_pk_bf16_f32 v70, v172, v173
v_cvt_pk_bf16_f32 v71, v174, v175
v_cvt_pk_bf16_f32 v78, v176, v177
v_cvt_pk_bf16_f32 v79, v178, v179
ds_write_b128 v3, v[60:63]
ds_write_b64 v3, v[70:71] offset:1024
ds_write_b64 v3, v[78:79] offset:1032
v_cvt_pk_bf16_f32 v36, v108, v109
v_cvt_pk_bf16_f32 v37, v110, v111
v_cvt_pk_bf16_f32 v38, v112, v113
v_cvt_pk_bf16_f32 v39, v114, v115
v_cvt_pk_bf16_f32 v40, v116, v117
v_cvt_pk_bf16_f32 v41, v118, v119
v_cvt_pk_bf16_f32 v42, v120, v121
v_cvt_pk_bf16_f32 v43, v122, v123
v_cvt_pk_bf16_f32 v44, v124, v125
v_cvt_pk_bf16_f32 v45, v126, v127
v_cvt_pk_bf16_f32 v46, v128, v129
v_cvt_pk_bf16_f32 v47, v130, v131
v_cvt_pk_bf16_f32 v52, v132, v133
v_cvt_pk_bf16_f32 v53, v134, v135
v_cvt_pk_bf16_f32 v66, v156, v157
v_cvt_pk_bf16_f32 v67, v158, v159
v_cvt_pk_bf16_f32 v54, v136, v137
v_cvt_pk_bf16_f32 v55, v138, v139
v_cvt_pk_bf16_f32 v74, v160, v161
v_cvt_pk_bf16_f32 v75, v162, v163
v_cvt_pk_bf16_f32 v56, v140, v141
v_cvt_pk_bf16_f32 v57, v142, v143
v_cvt_pk_bf16_f32 v68, v164, v165
v_cvt_pk_bf16_f32 v69, v166, v167
v_cvt_pk_bf16_f32 v58, v144, v145
v_cvt_pk_bf16_f32 v59, v146, v147
v_cvt_pk_bf16_f32 v76, v168, v169
v_cvt_pk_bf16_f32 v77, v170, v171
s_mov_b32 exec_lo, 0
s_mov_b32 exec_hi, 0xffff0000
v_mov_b32 v38, 0
v_mov_b32 v39, 0
v_mov_b32 v42, 0
v_mov_b32 v43, 0
v_mov_b32 v46, 0
v_mov_b32 v47, 0
s_mov_b64 exec, -1
v_mov_b32 v80, 0x3f803f80
v_mov_b32 v81, 0x3f803f80
v_mov_b32 v82, 0x3f803f80
v_mov_b32 v83, 0x3f803f80
v_mov_b32 v10, 0xf149f2ca
s_waitcnt lgkmcnt(0)
s_barrier
ds_read_b128 v[48:51], v4
ds_read_b64 v[64:65], v4 offset:1024
ds_read_b64 v[72:73], v4 offset:1032
v_mfma_f32_16x16x32_bf16 v[100:103], v[56:59], v[44:47], 0
v_mfma_f32_16x16x32_bf16 v[104:107], v[60:63], v[44:47], 0
v_mfma_f32_16x16x32_bf16 v[92:95], v[52:55], v[40:43], 0
v_mfma_f32_16x16x32_bf16 v[96:99], v[56:59], v[40:43], 0
v_mfma_f32_16x16x32_bf16 v[88:91], v[52:55], v[36:39], 0
s_waitcnt lgkmcnt(2)
v_mfma_f32_16x16x32_bf16 v[84:87], v[48:51], v[36:39], 0
s_mov_b32 s52, 0x3e8b97f6
s_nop 2
v_cndmask_b32 v100, v10, v100, s[56:57]
v_cndmask_b32 v101, v10, v101, s[58:59]
v_cndmask_b32 v102, v10, v102, s[60:61]
v_cndmask_b32 v103, v10, v103, s[62:63]
v_cndmask_b32 v104, v10, v104, s[64:65]
v_cndmask_b32 v105, v10, v105, s[66:67]
v_cndmask_b32 v106, v10, v106, s[68:69]
v_cndmask_b32 v107, v10, v107, s[70:71]
v_cndmask_b32 v92, v10, v92, s[56:57]
v_cndmask_b32 v93, v10, v93, s[58:59]
v_cndmask_b32 v94, v10, v94, s[60:61]
v_cndmask_b32 v95, v10, v95, s[62:63]
v_cndmask_b32 v96, v10, v96, s[64:65]
v_cndmask_b32 v97, v10, v97, s[66:67]
v_cndmask_b32 v98, v10, v98, s[68:69]
v_cndmask_b32 v99, v10, v99, s[70:71]
s_nop 0
v_cndmask_b32 v84, v10, v84, s[56:57]
v_cndmask_b32 v85, v10, v85, s[58:59]
v_cndmask_b32 v86, v10, v86, s[60:61]
v_cndmask_b32 v87, v10, v87, s[62:63]
v_cndmask_b32 v88, v10, v88, s[72:73]
v_cndmask_b32 v89, v10, v89, s[74:75]
v_cndmask_b32 v90, v10, v90, s[76:77]
v_cndmask_b32 v91, v10, v91, s[78:79]
v_max3_f32 v158, v100, v101, v102
v_max3_f32 v157, v92, v93, v94
v_max3_f32 v156, v84, v85, v86
v_max3_f32 v158, v158, v103, v104
v_max3_f32 v157, v157, v95, v96
v_max3_f32 v156, v156, v87, v88
v_max3_f32 v158, v158, v105, v106
v_max3_f32 v157, v157, v97, v98
v_max3_f32 v156, v156, v89, v90
v_max_f32 v158, v158, v107
v_max_f32 v157, v157, v99
v_max_f32 v156, v156, v91
v_mov_b32 v162, v158
v_mov_b32 v161, v157
v_mov_b32 v160, v156
v_permlane16_swap_b32 v158, v162
v_permlane16_swap_b32 v157, v161
v_permlane16_swap_b32 v156, v160
v_max_f32 v158, v158, v162
v_max_f32 v157, v157, v161
v_max_f32 v156, v156, v160
v_mov_b32 v162, v158
v_mov_b32 v161, v157
v_mov_b32 v160, v156
v_permlane32_swap_b32 v158, v162
v_permlane32_swap_b32 v157, v161
v_permlane32_swap_b32 v156, v160
v_max_f32 v158, v158, v162
v_max_f32 v157, v157, v161
v_max_f32 v156, v156, v160
v_mul_f32 v158, s52, v158
v_mul_f32 v157, s52, v157
v_mul_f32 v156, s52, v156
s_waitcnt lgkmcnt(0)
v_fma_f32 v100, v100, s52, -v158
v_fma_f32 v101, v101, s52, -v158
v_fma_f32 v102, v102, s52, -v158
v_fma_f32 v103, v103, s52, -v158
v_fma_f32 v104, v104, s52, -v158
v_fma_f32 v105, v105, s52, -v158
v_fma_f32 v106, v106, s52, -v158
v_fma_f32 v107, v107, s52, -v158
v_exp_f32 v100, v100
v_exp_f32 v101, v101
v_exp_f32 v102, v102
v_exp_f32 v103, v103
v_exp_f32 v104, v104
v_exp_f32 v105, v105
v_exp_f32 v106, v106
v_exp_f32 v107, v107
v_cvt_pk_bf16_f32 v116, v100, v101
v_cvt_pk_bf16_f32 v117, v102, v103
v_cvt_pk_bf16_f32 v118, v104, v105
v_cvt_pk_bf16_f32 v119, v106, v107
s_nop 1
v_mfma_f32_16x16x32_bf16 v[152:155], v[80:83], v[116:119], 0
v_mfma_f32_16x16x32_bf16 v[144:147], v[68:71], v[116:119], 0
v_mfma_f32_16x16x32_bf16 v[148:151], v[76:79], v[116:119], 0
v_fma_f32 v92, v92, s52, -v157
v_fma_f32 v93, v93, s52, -v157
v_fma_f32 v94, v94, s52, -v157
v_fma_f32 v95, v95, s52, -v157
v_fma_f32 v96, v96, s52, -v157
v_fma_f32 v97, v97, s52, -v157
v_fma_f32 v98, v98, s52, -v157
v_fma_f32 v99, v99, s52, -v157
v_exp_f32 v92, v92
v_exp_f32 v93, v93
v_exp_f32 v94, v94
v_exp_f32 v95, v95
v_exp_f32 v96, v96
v_exp_f32 v97, v97
v_exp_f32 v98, v98
v_exp_f32 v99, v99
v_cvt_pk_bf16_f32 v112, v92, v93
v_cvt_pk_bf16_f32 v113, v94, v95
v_cvt_pk_bf16_f32 v114, v96, v97
v_cvt_pk_bf16_f32 v115, v98, v99
s_nop 1
v_mfma_f32_16x16x32_bf16 v[140:143], v[80:83], v[112:115], 0
v_mfma_f32_16x16x32_bf16 v[132:135], v[66:69], v[112:115], 0
v_mfma_f32_16x16x32_bf16 v[136:139], v[74:77], v[112:115], 0
v_fma_f32 v84, v84, s52, -v156
v_fma_f32 v85, v85, s52, -v156
v_fma_f32 v86, v86, s52, -v156
v_fma_f32 v87, v87, s52, -v156
v_fma_f32 v88, v88, s52, -v156
v_fma_f32 v89, v89, s52, -v156
v_fma_f32 v90, v90, s52, -v156
v_fma_f32 v91, v91, s52, -v156
v_exp_f32 v84, v84
v_exp_f32 v85, v85
v_exp_f32 v86, v86
v_exp_f32 v87, v87
v_exp_f32 v88, v88
v_exp_f32 v89, v89
v_exp_f32 v90, v90
v_exp_f32 v91, v91
v_cvt_pk_bf16_f32 v108, v84, v85
v_cvt_pk_bf16_f32 v109, v86, v87
v_cvt_pk_bf16_f32 v110, v88, v89
v_cvt_pk_bf16_f32 v111, v90, v91
s_nop 1
v_mfma_f32_16x16x32_bf16 v[128:131], v[80:83], v[108:111], 0
v_mfma_f32_16x16x32_bf16 v[120:123], v[64:67], v[108:111], 0
v_mfma_f32_16x16x32_bf16 v[124:127], v[72:75], v[108:111], 0
s_mov_b32 s52, -1
s_mov_b32 s53, 0xffff
v_rcp_f32 v152, v152
s_nop 0
v_mul_f32 v144, v144, v152
v_mul_f32 v145, v145, v152
v_mul_f32 v146, v146, v152
v_mul_f32 v147, v147, v152
v_mul_f32 v148, v148, v152
v_mul_f32 v149, v149, v152
v_mul_f32 v150, v150, v152
v_mul_f32 v151, v151, v152
v_cvt_pk_bf16_f32 v172, v144, v145
v_cvt_pk_bf16_f32 v173, v146, v147
v_cvt_pk_bf16_f32 v174, v148, v149
v_cvt_pk_bf16_f32 v175, v150, v151
v_cndmask_b32 v174, 0, v174, s[52:53]
v_cndmask_b32 v175, 0, v175, s[52:53]
ds_write_b128 v14, v[172:175] offset:2048
ds_read_b128 v[188:191], v15 offset:2048
v_rcp_f32 v140, v140
s_nop 0
v_mul_f32 v132, v132, v140
v_mul_f32 v133, v133, v140
v_mul_f32 v134, v134, v140
v_mul_f32 v135, v135, v140
v_mul_f32 v136, v136, v140
v_mul_f32 v137, v137, v140
v_mul_f32 v138, v138, v140
v_mul_f32 v139, v139, v140
v_cvt_pk_bf16_f32 v168, v132, v133
v_cvt_pk_bf16_f32 v169, v134, v135
v_cvt_pk_bf16_f32 v170, v136, v137
v_cvt_pk_bf16_f32 v171, v138, v139
v_cndmask_b32 v170, 0, v170, s[52:53]
v_cndmask_b32 v171, 0, v171, s[52:53]
ds_write_b128 v14, v[168:171] offset:1024
ds_read_b128 v[184:187], v15 offset:1024
s_waitcnt lgkmcnt(2)
buffer_store_dwordx4 v[188:191], v13, s[40:43], 0 offen sc1
s_nop 1
v_rcp_f32 v128, v128
s_nop 0
v_mul_f32 v120, v120, v128
v_mul_f32 v121, v121, v128
v_mul_f32 v122, v122, v128
v_mul_f32 v123, v123, v128
v_mul_f32 v124, v124, v128
v_mul_f32 v125, v125, v128
v_mul_f32 v126, v126, v128
v_mul_f32 v127, v127, v128
v_cvt_pk_bf16_f32 v164, v120, v121
v_cvt_pk_bf16_f32 v165, v122, v123
v_cvt_pk_bf16_f32 v166, v124, v125
v_cvt_pk_bf16_f32 v167, v126, v127
v_cndmask_b32 v166, 0, v166, s[52:53]
v_cndmask_b32 v167, 0, v167, s[52:53]
ds_write_b128 v14, v[164:167] offset:0
ds_read_b128 v[180:183], v15 offset:0
s_waitcnt lgkmcnt(2)
buffer_store_dwordx4 v[184:187], v12, s[40:43], 0 offen sc1
s_waitcnt lgkmcnt(0)
buffer_store_dwordx4 v[180:183], v11, s[40:43], 0 offen sc1
s_branch L_k1_fin
L_dft:
s_mov_b32 s28, s4
s_mov_b32 s29, s5
s_mov_b32 s30, 1835008
s_mov_b32 s31, 0x20000
s_mov_b32 s32, s10
s_mov_b32 s33, s11
s_mov_b32 s34, 401408
s_mov_b32 s35, 0x20000
s_mov_b32 s36, s12
s_mov_b32 s37, s13
s_mov_b32 s38, 401408
s_mov_b32 s39, 0x20000
s_sub_u32 s48, s47, 24
s_lshl_b32 s49, s48, 3
s_add_u32 s49, s49, s45
s_lshl_b32 s50, s46, 2
s_add_u32 s50, s50, s44
s_lshl_b32 s51, s50, 4
s_cmp_eq_u32 s50, 15
s_cselect_b32 s32, s20, s32
s_cselect_b32 s33, s21, s33
s_cselect_b32 s34, 896, s34
s_cselect_b32 s52, 0, s51
v_lshrrev_b32 v2, 3, v1
v_and_b32 v3, 7, v1
v_lshrrev_b32 v4, 1, v2
v_xor_b32 v4, v3, v4
v_lshlrev_b32 v4, 4, v4
s_lshl_b32 s53, s44, 1
s_add_u32 s53, s53, s49
s_mul_i32 s53, s53, 896
s_mov_b32 s54, 57344
v_mad_u32_u24 v5, v2, s54, v4
v_add_u32 v32, s53, v5
v_xor_b32 v33, 64, v32
v_add_u32 v33, 458752, v33
s_movk_i32 s54, 896
v_mad_u32_u24 v5, v2, s54, v4
s_mul_i32 s55, s52, 896
v_add_u32 v34, s55, v5
v_xor_b32 v35, 64, v34
v_add_u32 v35, 7168, v35
s_lshl_b32 s56, s44, 12
s_add_u32 s56, s56, 1024
s_lshl_b32 s57, s44, 11
s_add_u32 s57, s57, 17408
s_mov_b32 s58, 917504
s_lshl_b32 s59, s47, 2
s_add_u32 s59, s59, s44
s_mov_b32 s64, s16
s_mov_b32 s65, s17
s_mov_b32 s66, 1204224
s_mov_b32 s67, 0x20000
v_and_b32 v2, 15, v1
v_lshrrev_b32 v3, 4, v1
v_lshl_add_u32 v3, v3, 7, s59
v_mul_u32_u24 v4, 11, v2
v_lshrrev_b32 v4, 5, v4
s_movk_i32 s60, 2688
s_mul_i32 s61, s46, 224
v_mul_u32_u24 v3, s60, v3
v_mul_u32_u24 v2, 108, v2
v_mul_u32_u24 v4, 572, v4
s_mov_b32 exec_lo, 0x1ff01ff
v_add3_u32 v3, v3, v2, v4
s_mov_b32 exec_hi, 0x1ff01ff
buffer_load_dword v206, v3, s[64:67], s61 offen
s_mov_b64 exec, -1
s_add_u32 m0, s57, 0
s_nop 0
buffer_load_dwordx4 v34, s[32:35], 0 offen offset:0 lds
s_add_u32 m0, s57, 1024
s_nop 0
buffer_load_dwordx4 v35, s[32:35], 0 offen offset:0 lds
s_add_u32 m0, s57, 8192
s_nop 0
buffer_load_dwordx4 v34, s[36:39], 0 offen offset:0 lds
s_add_u32 m0, s57, 9216
s_nop 0
buffer_load_dwordx4 v35, s[36:39], 0 offen offset:0 lds
s_add_u32 m0, s56, 0
s_nop 0
buffer_load_dwordx4 v32, s[28:31], 0 offen offset:0 lds
s_add_u32 m0, s56, 1024
s_nop 0
buffer_load_dwordx4 v33, s[28:31], 0 offen offset:0 lds
s_add_u32 m0, s56, 2048
s_nop 0
buffer_load_dwordx4 v32, s[28:31], s58 offen offset:0 lds
s_add_u32 m0, s56, 3072
s_nop 0
buffer_load_dwordx4 v33, s[28:31], s58 offen offset:0 lds
s_add_u32 m0, s57, 32640
v_lshrrev_b32 v2, 4, v1
buffer_load_dwordx4 v34, s[32:35], 0 offen offset:128 lds
v_and_b32 v3, 15, v1
v_lshrrev_b32 v4, 1, v3
v_xor_b32 v4, v4, v2
v_lshlrev_b32 v5, 7, v3
v_lshl_add_u32 v16, v4, 4, v5
v_xor_b32 v17, 64, v16
v_add_u32 v18, s57, v16
v_add_u32 v19, s57, v17
v_add_u32 v16, 1024, v16
v_add_u32 v17, 1024, v17
v_add_u32 v20, 32768, v16
v_add_u32 v21, 32768, v17
v_add_u32 v22, 32768, v18
v_add_u32 v23, 32768, v19
v_add_u32 v24, 65536, v16
v_add_u32 v25, 65536, v17
v_add_u32 v26, 65536, v18
v_add_u32 v27, 65536, v19
v_add_u32 v28, 98304, v16
s_add_u32 m0, s57, 33664
v_add_u32 v29, 98304, v17
buffer_load_dwordx4 v35, s[32:35], 0 offen offset:128 lds
v_add_u32 v30, 98304, v18
v_add_u32 v31, 98304, v19
v_cvt_f32_u32 v4, v3
v_mul_f32 v4, 0x3d000000, v4
v_add_f32 v5, 0.5, v4
v_lshlrev_b32 v6, 2, v2
v_cvt_f32_u32 v6, v6
v_add_f32 v36, 0x0, v6
v_add_f32 v37, 0x3f800000, v6
v_add_f32 v38, 0x40000000, v6
v_add_f32 v39, 0x40400000, v6
v_add_f32 v40, 0x41800000, v6
v_add_f32 v41, 0x41880000, v6
v_add_f32 v42, 0x41900000, v6
v_add_f32 v43, 0x41980000, v6
v_mul_f32 v44, v4, v36
v_mul_f32 v45, v4, v37
v_mul_f32 v46, v4, v38
v_mul_f32 v47, v4, v39
s_add_u32 m0, s57, 40832
v_mul_f32 v48, v4, v40
buffer_load_dwordx4 v34, s[36:39], 0 offen offset:128 lds
v_mul_f32 v49, v4, v41
v_mul_f32 v50, v4, v42
v_mul_f32 v51, v4, v43
v_fract_f32 v44, v44
v_fract_f32 v45, v45
v_fract_f32 v46, v46
v_fract_f32 v47, v47
v_fract_f32 v48, v48
v_fract_f32 v49, v49
v_fract_f32 v50, v50
v_fract_f32 v51, v51
v_cos_f32 v52, v44
v_cos_f32 v53, v45
v_cos_f32 v54, v46
v_cos_f32 v55, v47
v_cos_f32 v56, v48
v_cos_f32 v57, v49
v_cos_f32 v58, v50
v_cos_f32 v59, v51
s_add_u32 m0, s57, 41856
v_sin_f32 v60, v44
buffer_load_dwordx4 v35, s[36:39], 0 offen offset:128 lds
v_sin_f32 v61, v45
v_sin_f32 v62, v46
v_sin_f32 v63, v47
v_sin_f32 v64, v48
v_sin_f32 v65, v49
v_sin_f32 v66, v50
v_sin_f32 v67, v51
v_cvt_pk_bf16_f32 v180, v52, v53
v_cvt_pk_bf16_f32 v181, v54, v55
v_cvt_pk_bf16_f32 v182, v56, v57
v_cvt_pk_bf16_f32 v183, v58, v59
v_cvt_pk_bf16_f32 v188, v60, v61
v_cvt_pk_bf16_f32 v189, v62, v63
v_cvt_pk_bf16_f32 v190, v64, v65
v_cvt_pk_bf16_f32 v191, v66, v67
v_xor_b32 v196, 0x80008000, v188
v_xor_b32 v197, 0x80008000, v189
v_xor_b32 v198, 0x80008000, v190
v_xor_b32 v199, 0x80008000, v191
s_add_u32 m0, s56, 32640
v_mul_f32 v44, v5, v36
buffer_load_dwordx4 v32, s[28:31], 0 offen offset:128 lds
v_mul_f32 v45, v5, v37
v_mul_f32 v46, v5, v38
v_mul_f32 v47, v5, v39
v_mul_f32 v48, v5, v40
v_mul_f32 v49, v5, v41
v_mul_f32 v50, v5, v42
v_mul_f32 v51, v5, v43
v_fract_f32 v44, v44
v_fract_f32 v45, v45
v_fract_f32 v46, v46
v_fract_f32 v47, v47
v_fract_f32 v48, v48
v_fract_f32 v49, v49
v_fract_f32 v50, v50
v_fract_f32 v51, v51
v_cos_f32 v52, v44
v_cos_f32 v53, v45
v_cos_f32 v54, v46
v_cos_f32 v55, v47
s_add_u32 m0, s56, 33664
v_cos_f32 v56, v48
buffer_load_dwordx4 v33, s[28:31], 0 offen offset:128 lds
v_cos_f32 v57, v49
v_cos_f32 v58, v50
v_cos_f32 v59, v51
v_sin_f32 v60, v44
v_sin_f32 v61, v45
v_sin_f32 v62, v46
v_sin_f32 v63, v47
v_sin_f32 v64, v48
v_sin_f32 v65, v49
v_sin_f32 v66, v50
v_sin_f32 v67, v51
v_cvt_pk_bf16_f32 v184, v52, v53
v_cvt_pk_bf16_f32 v185, v54, v55
v_cvt_pk_bf16_f32 v186, v56, v57
v_cvt_pk_bf16_f32 v187, v58, v59
v_cvt_pk_bf16_f32 v192, v60, v61
v_cvt_pk_bf16_f32 v193, v62, v63
v_cvt_pk_bf16_f32 v194, v64, v65
v_cvt_pk_bf16_f32 v195, v66, v67
s_add_u32 m0, s56, 34688
v_xor_b32 v200, 0x80008000, v192
buffer_load_dwordx4 v32, s[28:31], s58 offen offset:128 lds
v_xor_b32 v201, 0x80008000, v193
v_xor_b32 v202, 0x80008000, v194
v_xor_b32 v203, 0x80008000, v195
s_lshl_b32 s59, s48, 1
s_add_u32 s59, s59, s45
s_lshl_b32 s59, s59, 12
s_lshl_b32 s60, s51, 4
s_add_u32 s59, s59, s60
s_add_u32 s59, s59, 2097152
v_lshlrev_b32 v11, 18, v2
v_lshl_add_u32 v11, v3, 4, v11
v_add_u32 v11, s59, v11
s_lshl_b32 s59, s49, 7
s_add_u32 s59, s59, 4194304
v_lshl_add_u32 v12, v2, 4, s59
v_cmp_eq_u32 vcc, 0, v3
v_bfrev_b32 v7, 1
s_nop 0
v_cndmask_b32 v12, v7, v12, vcc
s_add_u32 m0, s56, 35712
s_mov_b32 s96, s18
buffer_load_dwordx4 v33, s[28:31], s58 offen offset:128 lds
s_mov_b32 s97, s19
s_cmp_lt_u32 s2, 32
s_cselect_b32 s98, 0, 401408
s_mov_b32 s99, 0x20000
s_sub_u32 s88, s47, 4
s_mul_i32 s89, s88, 37
s_lshr_b32 s89, s89, 8
s_mul_i32 s89, s89, 7
s_sub_u32 s88, s88, s89
s_lshl_b32 s88, s88, 7
s_mul_i32 s89, s44, 7168
s_add_u32 s88, s88, s89
s_movk_i32 s89, 896
v_lshrrev_b32 v4, 3, v1
v_bfe_u32 v5, v1, 1, 2
v_lshrrev_b32 v6, 1, v4
v_xor_b32 v5, v5, v6
v_and_b32 v6, 1, v1
v_lshlrev_b32 v6, 4, v6
s_add_u32 m0, s57, 65280
v_lshl_add_u32 v5, v5, 5, v6
buffer_load_dwordx4 v34, s[32:35], 0 offen offset:256 lds
v_mad_u32_u24 v5, v4, s89, v5
v_add_u32 v204, s88, v5
s_lshl_b32 s100, s44, 10
s_lshl_b32 s88, s47, 2
s_add_u32 s88, s88, s44
s_mul_i32 s88, s88, 3136
v_lshl_add_u32 v207, v1, 7, s88
s_mov_b32 s3, 10240
s_mul_i32 s88, s46, 24
s_add_u32 s88, s88, s47
s_mul_i32 s89, s45, 160
s_add_u32 s88, s88, s89
s_sub_u32 s89, s2, 96
s_cmp_ge_u32 s47, 24
s_cselect_b32 s88, s89, s88
s_cselect_b32 s95, 5120, s3
s_cselect_b32 s3, -1, 0xffff
s_lshl_b32 s94, s88, 5
s_add_u32 s94, s94, 4259840
s_add_u32 m0, s57, 66304
s_mov_b32 s20, s22
buffer_load_dwordx4 v35, s[32:35], 0 offen offset:256 lds
s_mov_b32 s21, s23
s_mov_b32 s22, 1835008
s_mov_b32 s23, 0x20000
s_and_b32 s4, s2, 7
s_lshr_b32 s5, s2, 3
s_sub_u32 s5, s5, 4
s_mul_i32 s6, s5, 37
s_lshr_b32 s6, s6, 8
s_mul_i32 s7, s6, 7
s_sub_u32 s7, s5, s7
s_lshr_b32 s8, s6, 1
s_lshl_b32 s4, s4, 1
s_add_u32 s4, s4, s8
s_sub_u32 s8, 32, s4
s_cmp_eq_u32 s4, 0
s_cselect_b32 s8, 16, s8
s_bitcmp1_b32 s6, 0
s_cselect_b32 s4, s8, s4
s_sub_u32 s8, 32, s4
s_add_u32 m0, s57, 73472
s_and_b32 s8, s8, 31
buffer_load_dwordx4 v34, s[36:39], 0 offen offset:256 lds
s_lshl_b32 s9, s7, 2
s_add_u32 s9, s9, s44
s_lshl_b32 s9, s9, 4
v_and_b32 v3, 15, v1
v_lshrrev_b32 v2, 4, v1
v_add_u32 v4, s9, v3
v_sub_u32 v5, 448, v4
s_cmp_ge_u32 s9, 224
s_cselect_b32 s10, s8, s4
s_cselect_b64 vcc, -1, 0
s_lshl_b32 s10, s10, 16
s_add_u32 s10, s10, 2097152
v_cndmask_b32 v4, v4, v5, vcc
v_lshlrev_b32 v4, 4, v4
v_lshl_add_u32 v4, v2, 12, v4
v_add_u32 v244, s10, v4
s_lshl_b32 s11, s44, 4
v_add_u32 v4, s11, v3
v_lshlrev_b32 v5, 10, v2
s_add_u32 m0, s57, 74496
v_lshl_add_u32 v5, v4, 4, v5
buffer_load_dwordx4 v35, s[36:39], 0 offen offset:256 lds
s_lshl_b32 s12, s4, 16
v_add_u32 v245, s12, v5
v_and_b32 v5, 1, v4
v_lshl_add_u32 v5, v5, 5, s4
v_lshlrev_b32 v5, 5, v5
v_lshrrev_b32 v6, 1, v4
v_add_u32 v5, v5, v6
v_lshlrev_b32 v5, 2, v5
v_add_u32 v246, 4194304, v5
v_lshl_add_u32 v248, v4, 5, s4
s_movk_i32 s12, 896
v_mul_u32_u24 v5, s12, v248
v_lshl_add_u32 v5, v2, 3, v5
s_lshl_b32 s13, s7, 7
v_add_u32 v247, s13, v5
s_lshl_b32 s16, s44, 12
s_add_u32 s16, s16, 61440
v_bfe_u32 v4, v1, 2, 4
v_bfe_u32 v5, v1, 3, 2
s_add_u32 m0, s56, 65280
v_and_b32 v6, 3, v1
buffer_load_dwordx4 v32, s[28:31], 0 offen offset:256 lds
v_lshlrev_b32 v6, 3, v6
v_lshl_add_u32 v6, v4, 7, v6
v_lshl_add_u32 v250, v5, 5, v6
v_xor_b32 v251, 32, v250
v_xor_b32 v252, 64, v250
v_xor_b32 v253, 96, v250
v_lshlrev_b32 v254, 4, v1
v_add_u32 v254, 61440, v254
s_mov_b32 s61, s4
s_mul_i32 s61, s61, 5120
s_add_u32 s61, s61, 4259840
v_lshl_add_u32 v240, v1, 5, s61
v_mov_b32 v242, s94
v_mad_u32_u24 v242, v1, s95, v242
v_lshrrev_b32 v4, 3, v1
v_and_b32 v5, 7, v1
v_lshrrev_b32 v6, 1, v4
v_xor_b32 v5, v5, v6
v_lshlrev_b32 v5, 4, v5
s_add_u32 m0, s56, 66304
v_lshl_add_u32 v5, v4, 10, v5
buffer_load_dwordx4 v33, s[28:31], 0 offen offset:256 lds
s_lshl_b32 s61, s4, 16
s_lshl_b32 s62, s44, 14
s_add_u32 s61, s61, s62
v_add_u32 v245, s61, v5
v_xor_b32 v249, 64, v245
v_add_u32 v249, 8192, v249
s_add_u32 s15, s62, 77824
v_lshrrev_b32 v4, 1, v3
v_xor_b32 v4, v4, v2
v_lshlrev_b32 v4, 4, v4
v_lshl_add_u32 v4, v3, 7, v4
v_add_u32 v241, s15, v4
v_xor_b32 v243, 64, v241
s_lshl_b32 s61, s7, 2
s_add_u32 s61, s61, s44
s_mul_i32 s61, s61, 19
v_add_u32 v4, s61, v1
v_min_u32 v4, 511, v4
s_lshl_b32 s61, s4, 16
s_add_u32 m0, s56, 67328
v_lshl_add_u32 v255, v4, 7, s61
buffer_load_dwordx4 v32, s[28:31], s58 offen offset:256 lds
v_cvt_f32_u32 v4, v248
v_mul_f32 v4, 0x3a000000, v4
v_lshrrev_b32 v5, 1, v2
v_lshlrev_b32 v5, 3, v5
v_and_b32 v6, 1, v2
v_add_u32 v5, v5, v6
v_cvt_f32_u32 v5, v5
s_cmp_gt_u32 s7, 3
s_cselect_b32 s17, 0x80008000, 0
s_cmp_ge_u32 s7, 3
s_cselect_b32 s18, 0x80008000, 0
v_add_f32 v60, 0x0, v5
v_add_f32 v61, 0x40000000, v5
v_add_f32 v62, 0x40800000, v5
v_add_f32 v63, 0x40c00000, v5
v_add_f32 v64, 0x41800000, v5
v_add_f32 v65, 0x41900000, v5
v_add_f32 v66, 0x41a00000, v5
v_add_f32 v67, 0x41b00000, v5
s_add_u32 m0, s56, 68352
v_mul_f32 v60, v4, v60
buffer_load_dwordx4 v33, s[28:31], s58 offen offset:256 lds
v_mul_f32 v61, v4, v61
v_mul_f32 v62, v4, v62
v_mul_f32 v63, v4, v63
v_mul_f32 v64, v4, v64
v_mul_f32 v65, v4, v65
v_mul_f32 v66, v4, v66
v_mul_f32 v67, v4, v67
v_fract_f32 v60, v60
v_fract_f32 v61, v61
v_fract_f32 v62, v62
v_fract_f32 v63, v63
v_fract_f32 v64, v64
v_fract_f32 v65, v65
v_fract_f32 v66, v66
v_fract_f32 v67, v67
v_cos_f32 v68, v60
v_cos_f32 v69, v61
v_cos_f32 v70, v62
v_cos_f32 v71, v63
v_cos_f32 v72, v64
v_cos_f32 v73, v65
v_cos_f32 v74, v66
v_cos_f32 v75, v67
v_sin_f32 v76, v60
v_sin_f32 v77, v61
v_sin_f32 v78, v62
v_sin_f32 v79, v63
v_sin_f32 v80, v64
v_sin_f32 v81, v65
v_sin_f32 v82, v66
v_sin_f32 v83, v67
v_cvt_pk_bf16_f32 v208, v68, v69
v_cvt_pk_bf16_f32 v209, v70, v71
v_cvt_pk_bf16_f32 v210, v76, v77
v_cvt_pk_bf16_f32 v211, v78, v79
v_mov_b32 v224, v208
v_mov_b32 v225, v209
v_xor_b32 v226, s18, v210
v_xor_b32 v227, s18, v211
v_xor_b32 v210, s17, v210
v_xor_b32 v211, s17, v211
v_cvt_pk_bf16_f32 v212, v72, v73
v_cvt_pk_bf16_f32 v213, v74, v75
v_cvt_pk_bf16_f32 v214, v80, v81
v_cvt_pk_bf16_f32 v215, v82, v83
v_mov_b32 v228, v212
v_mov_b32 v229, v213
v_xor_b32 v230, s18, v214
v_xor_b32 v231, s18, v215
v_xor_b32 v214, s17, v214
v_xor_b32 v215, s17, v215
v_add_f32 v60, 0x42000000, v5
v_add_f32 v61, 0x42080000, v5
v_add_f32 v62, 0x42100000, v5
v_add_f32 v63, 0x42180000, v5
v_add_f32 v64, 0x42400000, v5
v_add_f32 v65, 0x42480000, v5
v_add_f32 v66, 0x42500000, v5
v_add_f32 v67, 0x42580000, v5
v_mul_f32 v60, v4, v60
v_mul_f32 v61, v4, v61
v_mul_f32 v62, v4, v62
v_mul_f32 v63, v4, v63
v_mul_f32 v64, v4, v64
v_mul_f32 v65, v4, v65
v_mul_f32 v66, v4, v66
v_mul_f32 v67, v4, v67
v_fract_f32 v60, v60
v_fract_f32 v61, v61
v_fract_f32 v62, v62
v_fract_f32 v63, v63
v_fract_f32 v64, v64
v_fract_f32 v65, v65
v_fract_f32 v66, v66
v_fract_f32 v67, v67
v_cos_f32 v68, v60
v_cos_f32 v69, v61
v_cos_f32 v70, v62
v_cos_f32 v71, v63
v_cos_f32 v72, v64
v_cos_f32 v73, v65
v_cos_f32 v74, v66
v_cos_f32 v75, v67
v_sin_f32 v76, v60
v_sin_f32 v77, v61
v_sin_f32 v78, v62
v_sin_f32 v79, v63
v_sin_f32 v80, v64
v_sin_f32 v81, v65
v_sin_f32 v82, v66
v_sin_f32 v83, v67
v_cvt_pk_bf16_f32 v216, v68, v69
v_cvt_pk_bf16_f32 v217, v70, v71
v_cvt_pk_bf16_f32 v218, v76, v77
v_cvt_pk_bf16_f32 v219, v78, v79
v_mov_b32 v232, v216
v_mov_b32 v233, v217
v_xor_b32 v234, s18, v218
v_xor_b32 v235, s18, v219
v_xor_b32 v218, s17, v218
v_xor_b32 v219, s17, v219
v_cvt_pk_bf16_f32 v220, v72, v73
v_cvt_pk_bf16_f32 v221, v74, v75
v_cvt_pk_bf16_f32 v222, v80, v81
v_cvt_pk_bf16_f32 v223, v82, v83
v_mov_b32 v236, v220
v_mov_b32 v237, v221
v_xor_b32 v238, s18, v222
v_xor_b32 v239, s18, v223
v_xor_b32 v222, s17, v222
v_xor_b32 v223, s17, v223
s_waitcnt vmcnt(16)
s_barrier
ds_read_b128 v[68:71], v18 offset:0
ds_read_b128 v[72:75], v18 offset:8192
ds_read_b128 v[36:39], v16 offset:0
ds_read_b128 v[40:43], v16 offset:2048
ds_read_b128 v[44:47], v16 offset:4096
ds_read_b128 v[48:51], v16 offset:6144
ds_read_b128 v[52:55], v16 offset:8192
ds_read_b128 v[56:59], v16 offset:10240
ds_read_b128 v[60:63], v16 offset:12288
ds_read_b128 v[64:67], v16 offset:14336
s_add_u32 m0, s57, 97920
s_waitcnt lgkmcnt(6)
v_mfma_f32_16x16x32_bf16 v[116:119], v[36:39], v[68:71], 0
buffer_load_dwordx4 v34, s[32:35], 0 offen offset:384 lds
v_mfma_f32_16x16x32_bf16 v[148:151], v[36:39], v[72:75], 0
ds_read_b128 v[108:111], v19 offset:0
v_mfma_f32_16x16x32_bf16 v[120:123], v[40:43], v[68:71], 0
ds_read_b128 v[112:115], v19 offset:8192
v_mfma_f32_16x16x32_bf16 v[152:155], v[40:43], v[72:75], 0
ds_read_b128 v[76:79], v17 offset:0
s_add_u32 m0, s57, 98944
s_waitcnt lgkmcnt(7)
v_mfma_f32_16x16x32_bf16 v[124:127], v[44:47], v[68:71], 0
buffer_load_dwordx4 v35, s[32:35], 0 offen offset:384 lds
v_mfma_f32_16x16x32_bf16 v[156:159], v[44:47], v[72:75], 0
ds_read_b128 v[80:83], v17 offset:2048
v_mfma_f32_16x16x32_bf16 v[128:131], v[48:51], v[68:71], 0
ds_read_b128 v[84:87], v17 offset:4096
v_mfma_f32_16x16x32_bf16 v[160:163], v[48:51], v[72:75], 0
ds_read_b128 v[88:91], v17 offset:6144
s_add_u32 m0, s57, 106112
s_waitcnt lgkmcnt(8)
v_mfma_f32_16x16x32_bf16 v[132:135], v[52:55], v[68:71], 0
buffer_load_dwordx4 v34, s[36:39], 0 offen offset:384 lds
v_mfma_f32_16x16x32_bf16 v[164:167], v[52:55], v[72:75], 0
ds_read_b128 v[92:95], v17 offset:8192
v_mfma_f32_16x16x32_bf16 v[136:139], v[56:59], v[68:71], 0
ds_read_b128 v[96:99], v17 offset:10240
v_mfma_f32_16x16x32_bf16 v[168:171], v[56:59], v[72:75], 0
ds_read_b128 v[100:103], v17 offset:12288
s_add_u32 m0, s57, 107136
s_waitcnt lgkmcnt(9)
v_mfma_f32_16x16x32_bf16 v[140:143], v[60:63], v[68:71], 0
buffer_load_dwordx4 v35, s[36:39], 0 offen offset:384 lds
v_mfma_f32_16x16x32_bf16 v[172:175], v[60:63], v[72:75], 0
ds_read_b128 v[104:107], v17 offset:14336
v_mfma_f32_16x16x32_bf16 v[144:147], v[64:67], v[68:71], 0
v_mfma_f32_16x16x32_bf16 v[176:179], v[64:67], v[72:75], 0
s_add_u32 m0, s56, 97920
s_waitcnt lgkmcnt(6)
v_mfma_f32_16x16x32_bf16 v[116:119], v[76:79], v[108:111], v[116:119]
buffer_load_dwordx4 v32, s[28:31], 0 offen offset:384 lds
v_mfma_f32_16x16x32_bf16 v[148:151], v[76:79], v[112:115], v[148:151]
v_mfma_f32_16x16x32_bf16 v[120:123], v[80:83], v[108:111], v[120:123]
v_mfma_f32_16x16x32_bf16 v[152:155], v[80:83], v[112:115], v[152:155]
s_add_u32 m0, s56, 98944
s_waitcnt lgkmcnt(4)
v_mfma_f32_16x16x32_bf16 v[124:127], v[84:87], v[108:111], v[124:127]
buffer_load_dwordx4 v33, s[28:31], 0 offen offset:384 lds
v_mfma_f32_16x16x32_bf16 v[156:159], v[84:87], v[112:115], v[156:159]
s_waitcnt lgkmcnt(0)
s_waitcnt vmcnt(14)
s_barrier
v_mfma_f32_16x16x32_bf16 v[128:131], v[88:91], v[108:111], v[128:131]
ds_read_b128 v[68:71], v22 offset:0
ds_read_b128 v[72:75], v22 offset:8192
v_mfma_f32_16x16x32_bf16 v[160:163], v[88:91], v[112:115], v[160:163]
ds_read_b128 v[36:39], v20 offset:0
ds_read_b128 v[40:43], v20 offset:2048
s_add_u32 m0, s56, 99968
v_mfma_f32_16x16x32_bf16 v[132:135], v[92:95], v[108:111], v[132:135]
buffer_load_dwordx4 v32, s[28:31], s58 offen offset:384 lds
v_mfma_f32_16x16x32_bf16 v[164:167], v[92:95], v[112:115], v[164:167]
ds_read_b128 v[44:47], v20 offset:4096
ds_read_b128 v[48:51], v20 offset:6144
v_mfma_f32_16x16x32_bf16 v[136:139], v[96:99], v[108:111], v[136:139]
ds_read_b128 v[52:55], v20 offset:8192
ds_read_b128 v[56:59], v20 offset:10240
v_mfma_f32_16x16x32_bf16 v[168:171], v[96:99], v[112:115], v[168:171]
ds_read_b128 v[60:63], v20 offset:12288
s_add_u32 m0, s56, 100992
v_mfma_f32_16x16x32_bf16 v[140:143], v[100:103], v[108:111], v[140:143]
buffer_load_dwordx4 v33, s[28:31], s58 offen offset:384 lds
v_mfma_f32_16x16x32_bf16 v[172:175], v[100:103], v[112:115], v[172:175]
ds_read_b128 v[64:67], v20 offset:14336
v_mfma_f32_16x16x32_bf16 v[144:147], v[104:107], v[108:111], v[144:147]
v_mfma_f32_16x16x32_bf16 v[176:179], v[104:107], v[112:115], v[176:179]
s_add_u32 m0, s57, -512
s_waitcnt lgkmcnt(6)
v_mfma_f32_16x16x32_bf16 v[116:119], v[36:39], v[68:71], v[116:119]
buffer_load_dwordx4 v34, s[32:35], 0 offen offset:512 lds
v_mfma_f32_16x16x32_bf16 v[148:151], v[36:39], v[72:75], v[148:151]
ds_read_b128 v[108:111], v23 offset:0
v_mfma_f32_16x16x32_bf16 v[120:123], v[40:43], v[68:71], v[120:123]
ds_read_b128 v[112:115], v23 offset:8192
v_mfma_f32_16x16x32_bf16 v[152:155], v[40:43], v[72:75], v[152:155]
ds_read_b128 v[76:79], v21 offset:0
s_add_u32 m0, s57, 512
s_waitcnt lgkmcnt(7)
v_mfma_f32_16x16x32_bf16 v[124:127], v[44:47], v[68:71], v[124:127]
buffer_load_dwordx4 v35, s[32:35], 0 offen offset:512 lds
v_mfma_f32_16x16x32_bf16 v[156:159], v[44:47], v[72:75], v[156:159]
ds_read_b128 v[80:83], v21 offset:2048
v_mfma_f32_16x16x32_bf16 v[128:131], v[48:51], v[68:71], v[128:131]
ds_read_b128 v[84:87], v21 offset:4096
v_mfma_f32_16x16x32_bf16 v[160:163], v[48:51], v[72:75], v[160:163]
ds_read_b128 v[88:91], v21 offset:6144
s_add_u32 m0, s57, 7680
s_waitcnt lgkmcnt(8)
v_mfma_f32_16x16x32_bf16 v[132:135], v[52:55], v[68:71], v[132:135]
buffer_load_dwordx4 v34, s[36:39], 0 offen offset:512 lds
v_mfma_f32_16x16x32_bf16 v[164:167], v[52:55], v[72:75], v[164:167]
ds_read_b128 v[92:95], v21 offset:8192
v_mfma_f32_16x16x32_bf16 v[136:139], v[56:59], v[68:71], v[136:139]
ds_read_b128 v[96:99], v21 offset:10240
v_mfma_f32_16x16x32_bf16 v[168:171], v[56:59], v[72:75], v[168:171]
ds_read_b128 v[100:103], v21 offset:12288
s_add_u32 m0, s57, 8704
s_waitcnt lgkmcnt(9)
v_mfma_f32_16x16x32_bf16 v[140:143], v[60:63], v[68:71], v[140:143]
buffer_load_dwordx4 v35, s[36:39], 0 offen offset:512 lds
v_mfma_f32_16x16x32_bf16 v[172:175], v[60:63], v[72:75], v[172:175]
ds_read_b128 v[104:107], v21 offset:14336
v_mfma_f32_16x16x32_bf16 v[144:147], v[64:67], v[68:71], v[144:147]
v_mfma_f32_16x16x32_bf16 v[176:179], v[64:67], v[72:75], v[176:179]
s_add_u32 m0, s56, -512
s_waitcnt lgkmcnt(6)
v_mfma_f32_16x16x32_bf16 v[116:119], v[76:79], v[108:111], v[116:119]
buffer_load_dwordx4 v32, s[28:31], 0 offen offset:512 lds
v_mfma_f32_16x16x32_bf16 v[148:151], v[76:79], v[112:115], v[148:151]
v_mfma_f32_16x16x32_bf16 v[120:123], v[80:83], v[108:111], v[120:123]
v_mfma_f32_16x16x32_bf16 v[152:155], v[80:83], v[112:115], v[152:155]
s_add_u32 m0, s56, 512
s_waitcnt lgkmcnt(4)
v_mfma_f32_16x16x32_bf16 v[124:127], v[84:87], v[108:111], v[124:127]
buffer_load_dwordx4 v33, s[28:31], 0 offen offset:512 lds
v_mfma_f32_16x16x32_bf16 v[156:159], v[84:87], v[112:115], v[156:159]
s_waitcnt lgkmcnt(0)
s_waitcnt vmcnt(14)
s_barrier
v_mfma_f32_16x16x32_bf16 v[128:131], v[88:91], v[108:111], v[128:131]
ds_read_b128 v[68:71], v26 offset:0
ds_read_b128 v[72:75], v26 offset:8192
v_mfma_f32_16x16x32_bf16 v[160:163], v[88:91], v[112:115], v[160:163]
ds_read_b128 v[36:39], v24 offset:0
ds_read_b128 v[40:43], v24 offset:2048
s_add_u32 m0, s56, 1536
v_mfma_f32_16x16x32_bf16 v[132:135], v[92:95], v[108:111], v[132:135]
buffer_load_dwordx4 v32, s[28:31], s58 offen offset:512 lds
v_mfma_f32_16x16x32_bf16 v[164:167], v[92:95], v[112:115], v[164:167]
ds_read_b128 v[44:47], v24 offset:4096
ds_read_b128 v[48:51], v24 offset:6144
v_mfma_f32_16x16x32_bf16 v[136:139], v[96:99], v[108:111], v[136:139]
ds_read_b128 v[52:55], v24 offset:8192
ds_read_b128 v[56:59], v24 offset:10240
v_mfma_f32_16x16x32_bf16 v[168:171], v[96:99], v[112:115], v[168:171]
ds_read_b128 v[60:63], v24 offset:12288
s_add_u32 m0, s56, 2560
v_mfma_f32_16x16x32_bf16 v[140:143], v[100:103], v[108:111], v[140:143]
buffer_load_dwordx4 v33, s[28:31], s58 offen offset:512 lds
v_mfma_f32_16x16x32_bf16 v[172:175], v[100:103], v[112:115], v[172:175]
ds_read_b128 v[64:67], v24 offset:14336
v_mfma_f32_16x16x32_bf16 v[144:147], v[104:107], v[108:111], v[144:147]
v_mfma_f32_16x16x32_bf16 v[176:179], v[104:107], v[112:115], v[176:179]
s_add_u32 m0, s57, 32128
s_waitcnt lgkmcnt(6)
v_mfma_f32_16x16x32_bf16 v[116:119], v[36:39], v[68:71], v[116:119]
buffer_load_dwordx4 v34, s[32:35], 0 offen offset:640 lds
v_mfma_f32_16x16x32_bf16 v[148:151], v[36:39], v[72:75], v[148:151]
ds_read_b128 v[108:111], v27 offset:0
v_mfma_f32_16x16x32_bf16 v[120:123], v[40:43], v[68:71], v[120:123]
ds_read_b128 v[112:115], v27 offset:8192
v_mfma_f32_16x16x32_bf16 v[152:155], v[40:43], v[72:75], v[152:155]
ds_read_b128 v[76:79], v25 offset:0
s_add_u32 m0, s57, 33152
s_waitcnt lgkmcnt(7)
v_mfma_f32_16x16x32_bf16 v[124:127], v[44:47], v[68:71], v[124:127]
buffer_load_dwordx4 v35, s[32:35], 0 offen offset:640 lds
v_mfma_f32_16x16x32_bf16 v[156:159], v[44:47], v[72:75], v[156:159]
ds_read_b128 v[80:83], v25 offset:2048
v_mfma_f32_16x16x32_bf16 v[128:131], v[48:51], v[68:71], v[128:131]
ds_read_b128 v[84:87], v25 offset:4096
v_mfma_f32_16x16x32_bf16 v[160:163], v[48:51], v[72:75], v[160:163]
ds_read_b128 v[88:91], v25 offset:6144
s_add_u32 m0, s57, 40320
s_waitcnt lgkmcnt(8)
v_mfma_f32_16x16x32_bf16 v[132:135], v[52:55], v[68:71], v[132:135]
buffer_load_dwordx4 v34, s[36:39], 0 offen offset:640 lds
v_mfma_f32_16x16x32_bf16 v[164:167], v[52:55], v[72:75], v[164:167]
ds_read_b128 v[92:95], v25 offset:8192
v_mfma_f32_16x16x32_bf16 v[136:139], v[56:59], v[68:71], v[136:139]
ds_read_b128 v[96:99], v25 offset:10240
v_mfma_f32_16x16x32_bf16 v[168:171], v[56:59], v[72:75], v[168:171]
ds_read_b128 v[100:103], v25 offset:12288
s_add_u32 m0, s57, 41344
s_waitcnt lgkmcnt(9)
v_mfma_f32_16x16x32_bf16 v[140:143], v[60:63], v[68:71], v[140:143]
buffer_load_dwordx4 v35, s[36:39], 0 offen offset:640 lds
v_mfma_f32_16x16x32_bf16 v[172:175], v[60:63], v[72:75], v[172:175]
ds_read_b128 v[104:107], v25 offset:14336
v_mfma_f32_16x16x32_bf16 v[144:147], v[64:67], v[68:71], v[144:147]
v_mfma_f32_16x16x32_bf16 v[176:179], v[64:67], v[72:75], v[176:179]
s_add_u32 m0, s56, 32128
s_waitcnt lgkmcnt(6)
v_mfma_f32_16x16x32_bf16 v[116:119], v[76:79], v[108:111], v[116:119]
buffer_load_dwordx4 v32, s[28:31], 0 offen offset:640 lds
v_mfma_f32_16x16x32_bf16 v[148:151], v[76:79], v[112:115], v[148:151]
v_mfma_f32_16x16x32_bf16 v[120:123], v[80:83], v[108:111], v[120:123]
v_mfma_f32_16x16x32_bf16 v[152:155], v[80:83], v[112:115], v[152:155]
s_add_u32 m0, s56, 33152
s_waitcnt lgkmcnt(4)
v_mfma_f32_16x16x32_bf16 v[124:127], v[84:87], v[108:111], v[124:127]
buffer_load_dwordx4 v33, s[28:31], 0 offen offset:640 lds
v_mfma_f32_16x16x32_bf16 v[156:159], v[84:87], v[112:115], v[156:159]
s_waitcnt lgkmcnt(0)
s_waitcnt vmcnt(14)
s_barrier
v_mfma_f32_16x16x32_bf16 v[128:131], v[88:91], v[108:111], v[128:131]
ds_read_b128 v[68:71], v30 offset:0
ds_read_b128 v[72:75], v30 offset:8192
v_mfma_f32_16x16x32_bf16 v[160:163], v[88:91], v[112:115], v[160:163]
ds_read_b128 v[36:39], v28 offset:0
ds_read_b128 v[40:43], v28 offset:2048
s_add_u32 m0, s56, 34176
v_mfma_f32_16x16x32_bf16 v[132:135], v[92:95], v[108:111], v[132:135]
buffer_load_dwordx4 v32, s[28:31], s58 offen offset:640 lds
v_mfma_f32_16x16x32_bf16 v[164:167], v[92:95], v[112:115], v[164:167]
ds_read_b128 v[44:47], v28 offset:4096
ds_read_b128 v[48:51], v28 offset:6144
v_mfma_f32_16x16x32_bf16 v[136:139], v[96:99], v[108:111], v[136:139]
ds_read_b128 v[52:55], v28 offset:8192
ds_read_b128 v[56:59], v28 offset:10240
v_mfma_f32_16x16x32_bf16 v[168:171], v[96:99], v[112:115], v[168:171]
ds_read_b128 v[60:63], v28 offset:12288
s_add_u32 m0, s56, 35200
v_mfma_f32_16x16x32_bf16 v[140:143], v[100:103], v[108:111], v[140:143]
buffer_load_dwordx4 v33, s[28:31], s58 offen offset:640 lds
v_mfma_f32_16x16x32_bf16 v[172:175], v[100:103], v[112:115], v[172:175]
ds_read_b128 v[64:67], v28 offset:14336
v_mfma_f32_16x16x32_bf16 v[144:147], v[104:107], v[108:111], v[144:147]
v_mfma_f32_16x16x32_bf16 v[176:179], v[104:107], v[112:115], v[176:179]
s_add_u32 m0, s57, 64768
s_waitcnt lgkmcnt(6)
v_mfma_f32_16x16x32_bf16 v[116:119], v[36:39], v[68:71], v[116:119]
buffer_load_dwordx4 v34, s[32:35], 0 offen offset:768 lds
v_mfma_f32_16x16x32_bf16 v[148:151], v[36:39], v[72:75], v[148:151]
ds_read_b128 v[108:111], v31 offset:0
v_mfma_f32_16x16x32_bf16 v[120:123], v[40:43], v[68:71], v[120:123]
ds_read_b128 v[112:115], v31 offset:8192
v_mfma_f32_16x16x32_bf16 v[152:155], v[40:43], v[72:75], v[152:155]
ds_read_b128 v[76:79], v29 offset:0
s_add_u32 m0, s57, 65792
s_waitcnt lgkmcnt(7)
v_mfma_f32_16x16x32_bf16 v[124:127], v[44:47], v[68:71], v[124:127]
buffer_load_dwordx4 v35, s[32:35], 0 offen offset:768 lds
v_mfma_f32_16x16x32_bf16 v[156:159], v[44:47], v[72:75], v[156:159]
ds_read_b128 v[80:83], v29 offset:2048
v_mfma_f32_16x16x32_bf16 v[128:131], v[48:51], v[68:71], v[128:131]
ds_read_b128 v[84:87], v29 offset:4096
v_mfma_f32_16x16x32_bf16 v[160:163], v[48:51], v[72:75], v[160:163]
ds_read_b128 v[88:91], v29 offset:6144
s_add_u32 m0, s57, 72960
s_waitcnt lgkmcnt(8)
v_mfma_f32_16x16x32_bf16 v[132:135], v[52:55], v[68:71], v[132:135]
buffer_load_dwordx4 v34, s[36:39], 0 offen offset:768 lds
v_mfma_f32_16x16x32_bf16 v[164:167], v[52:55], v[72:75], v[164:167]
ds_read_b128 v[92:95], v29 offset:8192
v_mfma_f32_16x16x32_bf16 v[136:139], v[56:59], v[68:71], v[136:139]
ds_read_b128 v[96:99], v29 offset:10240
v_mfma_f32_16x16x32_bf16 v[168:171], v[56:59], v[72:75], v[168:171]
ds_read_b128 v[100:103], v29 offset:12288
s_add_u32 m0, s57, 73984
s_waitcnt lgkmcnt(9)
v_mfma_f32_16x16x32_bf16 v[140:143], v[60:63], v[68:71], v[140:143]
buffer_load_dwordx4 v35, s[36:39], 0 offen offset:768 lds
v_mfma_f32_16x16x32_bf16 v[172:175], v[60:63], v[72:75], v[172:175]
ds_read_b128 v[104:107], v29 offset:14336
v_mfma_f32_16x16x32_bf16 v[144:147], v[64:67], v[68:71], v[144:147]
v_mfma_f32_16x16x32_bf16 v[176:179], v[64:67], v[72:75], v[176:179]
s_add_u32 m0, s56, 64768
s_waitcnt lgkmcnt(6)
v_mfma_f32_16x16x32_bf16 v[116:119], v[76:79], v[108:111], v[116:119]
buffer_load_dwordx4 v32, s[28:31], 0 offen offset:768 lds
v_mfma_f32_16x16x32_bf16 v[148:151], v[76:79], v[112:115], v[148:151]
v_mfma_f32_16x16x32_bf16 v[120:123], v[80:83], v[108:111], v[120:123]
v_mfma_f32_16x16x32_bf16 v[152:155], v[80:83], v[112:115], v[152:155]
s_add_u32 m0, s56, 65792
s_waitcnt lgkmcnt(4)
v_mfma_f32_16x16x32_bf16 v[124:127], v[84:87], v[108:111], v[124:127]
buffer_load_dwordx4 v33, s[28:31], 0 offen offset:768 lds
v_mfma_f32_16x16x32_bf16 v[156:159], v[84:87], v[112:115], v[156:159]
s_waitcnt lgkmcnt(0)
s_waitcnt vmcnt(14)
s_barrier
v_mfma_f32_16x16x32_bf16 v[128:131], v[88:91], v[108:111], v[128:131]
ds_read_b128 v[68:71], v18 offset:0
ds_read_b128 v[72:75], v18 offset:8192
v_mfma_f32_16x16x32_bf16 v[160:163], v[88:91], v[112:115], v[160:163]
ds_read_b128 v[36:39], v16 offset:0
ds_read_b128 v[40:43], v16 offset:2048
s_add_u32 m0, s56, 66816
v_mfma_f32_16x16x32_bf16 v[132:135], v[92:95], v[108:111], v[132:135]
buffer_load_dwordx4 v32, s[28:31], s58 offen offset:768 lds
v_mfma_f32_16x16x32_bf16 v[164:167], v[92:95], v[112:115], v[164:167]
ds_read_b128 v[44:47], v16 offset:4096
ds_read_b128 v[48:51], v16 offset:6144
v_mfma_f32_16x16x32_bf16 v[136:139], v[96:99], v[108:111], v[136:139]
ds_read_b128 v[52:55], v16 offset:8192
ds_read_b128 v[56:59], v16 offset:10240
v_mfma_f32_16x16x32_bf16 v[168:171], v[96:99], v[112:115], v[168:171]
ds_read_b128 v[60:63], v16 offset:12288
s_add_u32 m0, s56, 67840
v_mfma_f32_16x16x32_bf16 v[140:143], v[100:103], v[108:111], v[140:143]
buffer_load_dwordx4 v33, s[28:31], s58 offen offset:768 lds
v_mfma_f32_16x16x32_bf16 v[172:175], v[100:103], v[112:115], v[172:175]
ds_read_b128 v[64:67], v16 offset:14336
v_mfma_f32_16x16x32_bf16 v[144:147], v[104:107], v[108:111], v[144:147]
v_mfma_f32_16x16x32_bf16 v[176:179], v[104:107], v[112:115], v[176:179]
s_waitcnt lgkmcnt(6)
v_mfma_f32_16x16x32_bf16 v[116:119], v[36:39], v[68:71], v[116:119]
buffer_load_dword v205, off, s[24:27], 0 sc1
v_mfma_f32_16x16x32_bf16 v[148:151], v[36:39], v[72:75], v[148:151]
ds_read_b128 v[108:111], v19 offset:0
v_mfma_f32_16x16x32_bf16 v[120:123], v[40:43], v[68:71], v[120:123]
ds_read_b128 v[112:115], v19 offset:8192
v_mfma_f32_16x16x32_bf16 v[152:155], v[40:43], v[72:75], v[152:155]
ds_read_b128 v[76:79], v17 offset:0
s_add_u32 m0, s100, 110592
s_mov_b32 s89, 0
s_waitcnt lgkmcnt(7)
v_mfma_f32_16x16x32_bf16 v[124:127], v[44:47], v[68:71], v[124:127]
buffer_load_dwordx4 v204, s[96:99], s89 offen lds
v_mfma_f32_16x16x32_bf16 v[156:159], v[44:47], v[72:75], v[156:159]
ds_read_b128 v[80:83], v17 offset:2048
v_mfma_f32_16x16x32_bf16 v[128:131], v[48:51], v[68:71], v[128:131]
ds_read_b128 v[84:87], v17 offset:4096
v_mfma_f32_16x16x32_bf16 v[160:163], v[48:51], v[72:75], v[160:163]
ds_read_b128 v[88:91], v17 offset:6144
s_add_u32 m0, s100, 114688
s_mov_b32 s89, 28672
s_waitcnt lgkmcnt(8)
v_mfma_f32_16x16x32_bf16 v[132:135], v[52:55], v[68:71], v[132:135]
buffer_load_dwordx4 v204, s[96:99], s89 offen lds
v_mfma_f32_16x16x32_bf16 v[164:167], v[52:55], v[72:75], v[164:167]
ds_read_b128 v[92:95], v17 offset:8192
v_mfma_f32_16x16x32_bf16 v[136:139], v[56:59], v[68:71], v[136:139]
ds_read_b128 v[96:99], v17 offset:10240
v_mfma_f32_16x16x32_bf16 v[168:171], v[56:59], v[72:75], v[168:171]
ds_read_b128 v[100:103], v17 offset:12288
s_add_u32 m0, s100, 118784
s_mov_b32 s89, 57344
s_waitcnt lgkmcnt(9)
v_mfma_f32_16x16x32_bf16 v[140:143], v[60:63], v[68:71], v[140:143]
buffer_load_dwordx4 v204, s[96:99], s89 offen lds
v_mfma_f32_16x16x32_bf16 v[172:175], v[60:63], v[72:75], v[172:175]
ds_read_b128 v[104:107], v17 offset:14336
v_mfma_f32_16x16x32_bf16 v[144:147], v[64:67], v[68:71], v[144:147]
v_mfma_f32_16x16x32_bf16 v[176:179], v[64:67], v[72:75], v[176:179]
s_add_u32 m0, s100, 122880
s_mov_b32 s89, 86016
s_waitcnt lgkmcnt(6)
v_mfma_f32_16x16x32_bf16 v[116:119], v[76:79], v[108:111], v[116:119]
buffer_load_dwordx4 v204, s[96:99], s89 offen lds
v_mfma_f32_16x16x32_bf16 v[148:151], v[76:79], v[112:115], v[148:151]
v_mfma_f32_16x16x32_bf16 v[120:123], v[80:83], v[108:111], v[120:123]
v_mfma_f32_16x16x32_bf16 v[152:155], v[80:83], v[112:115], v[152:155]
s_add_u32 m0, s100, 126976
s_mov_b32 s89, 114688
s_waitcnt lgkmcnt(4)
v_mfma_f32_16x16x32_bf16 v[124:127], v[84:87], v[108:111], v[124:127]
buffer_load_dwordx4 v204, s[96:99], s89 offen lds
v_mfma_f32_16x16x32_bf16 v[156:159], v[84:87], v[112:115], v[156:159]
s_waitcnt lgkmcnt(0)
s_waitcnt vmcnt(14)
s_barrier
v_mfma_f32_16x16x32_bf16 v[128:131], v[88:91], v[108:111], v[128:131]
ds_read_b128 v[68:71], v22 offset:0
ds_read_b128 v[72:75], v22 offset:8192
v_mfma_f32_16x16x32_bf16 v[160:163], v[88:91], v[112:115], v[160:163]
ds_read_b128 v[36:39], v20 offset:0
ds_read_b128 v[40:43], v20 offset:2048
s_add_u32 m0, s100, 131072
s_mov_b32 s89, 143360
v_mfma_f32_16x16x32_bf16 v[132:135], v[92:95], v[108:111], v[132:135]
buffer_load_dwordx4 v204, s[96:99], s89 offen lds
v_mfma_f32_16x16x32_bf16 v[164:167], v[92:95], v[112:115], v[164:167]
ds_read_b128 v[44:47], v20 offset:4096
ds_read_b128 v[48:51], v20 offset:6144
v_mfma_f32_16x16x32_bf16 v[136:139], v[96:99], v[108:111], v[136:139]
ds_read_b128 v[52:55], v20 offset:8192
ds_read_b128 v[56:59], v20 offset:10240
v_mfma_f32_16x16x32_bf16 v[168:171], v[96:99], v[112:115], v[168:171]
ds_read_b128 v[60:63], v20 offset:12288
s_add_u32 m0, s100, 135168
s_mov_b32 s89, 172032
v_mfma_f32_16x16x32_bf16 v[140:143], v[100:103], v[108:111], v[140:143]
buffer_load_dwordx4 v204, s[96:99], s89 offen lds
v_mfma_f32_16x16x32_bf16 v[172:175], v[100:103], v[112:115], v[172:175]
ds_read_b128 v[64:67], v20 offset:14336
v_mfma_f32_16x16x32_bf16 v[144:147], v[104:107], v[108:111], v[144:147]
v_mfma_f32_16x16x32_bf16 v[176:179], v[104:107], v[112:115], v[176:179]
s_add_u32 m0, s100, 139264
s_mov_b32 s89, 200704
s_waitcnt lgkmcnt(6)
v_mfma_f32_16x16x32_bf16 v[116:119], v[36:39], v[68:71], v[116:119]
buffer_load_dwordx4 v204, s[96:99], s89 offen lds
v_mfma_f32_16x16x32_bf16 v[148:151], v[36:39], v[72:75], v[148:151]
ds_read_b128 v[108:111], v23 offset:0
v_mfma_f32_16x16x32_bf16 v[120:123], v[40:43], v[68:71], v[120:123]
ds_read_b128 v[112:115], v23 offset:8192
v_mfma_f32_16x16x32_bf16 v[152:155], v[40:43], v[72:75], v[152:155]
ds_read_b128 v[76:79], v21 offset:0
s_add_u32 m0, s100, 0
s_mov_b32 s89, 200704
s_waitcnt lgkmcnt(7)
v_mfma_f32_16x16x32_bf16 v[124:127], v[44:47], v[68:71], v[124:127]
buffer_load_dwordx4 v204, s[96:99], s89 offen lds
v_mfma_f32_16x16x32_bf16 v[156:159], v[44:47], v[72:75], v[156:159]
ds_read_b128 v[80:83], v21 offset:2048
v_mfma_f32_16x16x32_bf16 v[128:131], v[48:51], v[68:71], v[128:131]
ds_read_b128 v[84:87], v21 offset:4096
v_mfma_f32_16x16x32_bf16 v[160:163], v[48:51], v[72:75], v[160:163]
ds_read_b128 v[88:91], v21 offset:6144
s_add_u32 m0, s100, 4096
s_mov_b32 s89, 229376
s_waitcnt lgkmcnt(8)
v_mfma_f32_16x16x32_bf16 v[132:135], v[52:55], v[68:71], v[132:135]
buffer_load_dwordx4 v204, s[96:99], s89 offen lds
v_mfma_f32_16x16x32_bf16 v[164:167], v[52:55], v[72:75], v[164:167]
ds_read_b128 v[92:95], v21 offset:8192
v_mfma_f32_16x16x32_bf16 v[136:139], v[56:59], v[68:71], v[136:139]
ds_read_b128 v[96:99], v21 offset:10240
v_mfma_f32_16x16x32_bf16 v[168:171], v[56:59], v[72:75], v[168:171]
ds_read_b128 v[100:103], v21 offset:12288
s_add_u32 m0, s100, 8192
s_mov_b32 s89, 258048
s_waitcnt lgkmcnt(9)
v_mfma_f32_16x16x32_bf16 v[140:143], v[60:63], v[68:71], v[140:143]
buffer_load_dwordx4 v204, s[96:99], s89 offen lds
v_mfma_f32_16x16x32_bf16 v[172:175], v[60:63], v[72:75], v[172:175]
ds_read_b128 v[104:107], v21 offset:14336
v_mfma_f32_16x16x32_bf16 v[144:147], v[64:67], v[68:71], v[144:147]
v_mfma_f32_16x16x32_bf16 v[176:179], v[64:67], v[72:75], v[176:179]
s_add_u32 m0, s100, 12288
s_mov_b32 s89, 286720
s_waitcnt lgkmcnt(6)
v_mfma_f32_16x16x32_bf16 v[116:119], v[76:79], v[108:111], v[116:119]
buffer_load_dwordx4 v204, s[96:99], s89 offen lds
v_mfma_f32_16x16x32_bf16 v[148:151], v[76:79], v[112:115], v[148:151]
v_mfma_f32_16x16x32_bf16 v[120:123], v[80:83], v[108:111], v[120:123]
v_mfma_f32_16x16x32_bf16 v[152:155], v[80:83], v[112:115], v[152:155]
s_add_u32 m0, s100, 16384
s_mov_b32 s89, 315392
s_waitcnt lgkmcnt(4)
v_mfma_f32_16x16x32_bf16 v[124:127], v[84:87], v[108:111], v[124:127]
buffer_load_dwordx4 v204, s[96:99], s89 offen lds
v_mfma_f32_16x16x32_bf16 v[156:159], v[84:87], v[112:115], v[156:159]
s_waitcnt lgkmcnt(0)
s_waitcnt vmcnt(14)
s_barrier
v_mfma_f32_16x16x32_bf16 v[128:131], v[88:91], v[108:111], v[128:131]
ds_read_b128 v[68:71], v26 offset:0
ds_read_b128 v[72:75], v26 offset:8192
v_mfma_f32_16x16x32_bf16 v[160:163], v[88:91], v[112:115], v[160:163]
ds_read_b128 v[36:39], v24 offset:0
ds_read_b128 v[40:43], v24 offset:2048
s_add_u32 m0, s100, 20480
s_mov_b32 s89, 344064
v_mfma_f32_16x16x32_bf16 v[132:135], v[92:95], v[108:111], v[132:135]
buffer_load_dwordx4 v204, s[96:99], s89 offen lds
v_mfma_f32_16x16x32_bf16 v[164:167], v[92:95], v[112:115], v[164:167]
ds_read_b128 v[44:47], v24 offset:4096
ds_read_b128 v[48:51], v24 offset:6144
v_mfma_f32_16x16x32_bf16 v[136:139], v[96:99], v[108:111], v[136:139]
ds_read_b128 v[52:55], v24 offset:8192
ds_read_b128 v[56:59], v24 offset:10240
v_mfma_f32_16x16x32_bf16 v[168:171], v[96:99], v[112:115], v[168:171]
ds_read_b128 v[60:63], v24 offset:12288
s_add_u32 m0, s100, 24576
s_mov_b32 s89, 372736
v_mfma_f32_16x16x32_bf16 v[140:143], v[100:103], v[108:111], v[140:143]
buffer_load_dwordx4 v204, s[96:99], s89 offen lds
v_mfma_f32_16x16x32_bf16 v[172:175], v[100:103], v[112:115], v[172:175]
ds_read_b128 v[64:67], v24 offset:14336
v_mfma_f32_16x16x32_bf16 v[144:147], v[104:107], v[108:111], v[144:147]
v_mfma_f32_16x16x32_bf16 v[176:179], v[104:107], v[112:115], v[176:179]
s_add_u32 m0, s100, 28672
s_mov_b32 s89, 401408
s_waitcnt lgkmcnt(6)
v_mfma_f32_16x16x32_bf16 v[116:119], v[36:39], v[68:71], v[116:119]
buffer_load_dwordx4 v204, s[96:99], s89 offen lds
v_mfma_f32_16x16x32_bf16 v[148:151], v[36:39], v[72:75], v[148:151]
ds_read_b128 v[108:111], v27 offset:0
v_mfma_f32_16x16x32_bf16 v[120:123], v[40:43], v[68:71], v[120:123]
ds_read_b128 v[112:115], v27 offset:8192
v_mfma_f32_16x16x32_bf16 v[152:155], v[40:43], v[72:75], v[152:155]
ds_read_b128 v[76:79], v25 offset:0
s_waitcnt lgkmcnt(7)
v_mfma_f32_16x16x32_bf16 v[124:127], v[44:47], v[68:71], v[124:127]
ds_read_b128 v[80:83], v25 offset:2048
v_mfma_f32_16x16x32_bf16 v[156:159], v[44:47], v[72:75], v[156:159]
ds_read_b128 v[84:87], v25 offset:4096
v_mfma_f32_16x16x32_bf16 v[128:131], v[48:51], v[68:71], v[128:131]
ds_read_b128 v[88:91], v25 offset:6144
v_mfma_f32_16x16x32_bf16 v[160:163], v[48:51], v[72:75], v[160:163]
ds_read_b128 v[92:95], v25 offset:8192
s_waitcnt lgkmcnt(9)
v_mfma_f32_16x16x32_bf16 v[132:135], v[52:55], v[68:71], v[132:135]
ds_read_b128 v[96:99], v25 offset:10240
v_mfma_f32_16x16x32_bf16 v[164:167], v[52:55], v[72:75], v[164:167]
ds_read_b128 v[100:103], v25 offset:12288
v_mfma_f32_16x16x32_bf16 v[136:139], v[56:59], v[68:71], v[136:139]
ds_read_b128 v[104:107], v25 offset:14336
v_mfma_f32_16x16x32_bf16 v[168:171], v[56:59], v[72:75], v[168:171]
s_waitcnt lgkmcnt(10)
v_mfma_f32_16x16x32_bf16 v[140:143], v[60:63], v[68:71], v[140:143]
v_mfma_f32_16x16x32_bf16 v[172:175], v[60:63], v[72:75], v[172:175]
v_mfma_f32_16x16x32_bf16 v[144:147], v[64:67], v[68:71], v[144:147]
v_mfma_f32_16x16x32_bf16 v[176:179], v[64:67], v[72:75], v[176:179]
s_waitcnt lgkmcnt(6)
v_mfma_f32_16x16x32_bf16 v[116:119], v[76:79], v[108:111], v[116:119]
v_mfma_f32_16x16x32_bf16 v[148:151], v[76:79], v[112:115], v[148:151]
v_mfma_f32_16x16x32_bf16 v[120:123], v[80:83], v[108:111], v[120:123]
v_mfma_f32_16x16x32_bf16 v[152:155], v[80:83], v[112:115], v[152:155]
s_waitcnt lgkmcnt(4)
v_mfma_f32_16x16x32_bf16 v[124:127], v[84:87], v[108:111], v[124:127]
v_mfma_f32_16x16x32_bf16 v[156:159], v[84:87], v[112:115], v[156:159]
v_mfma_f32_16x16x32_bf16 v[128:131], v[88:91], v[108:111], v[128:131]
v_mfma_f32_16x16x32_bf16 v[160:163], v[88:91], v[112:115], v[160:163]
s_waitcnt lgkmcnt(2)
v_mfma_f32_16x16x32_bf16 v[132:135], v[92:95], v[108:111], v[132:135]
v_mfma_f32_16x16x32_bf16 v[164:167], v[92:95], v[112:115], v[164:167]
v_mfma_f32_16x16x32_bf16 v[136:139], v[96:99], v[108:111], v[136:139]
v_mfma_f32_16x16x32_bf16 v[168:171], v[96:99], v[112:115], v[168:171]
s_waitcnt lgkmcnt(0)
v_mfma_f32_16x16x32_bf16 v[140:143], v[100:103], v[108:111], v[140:143]
v_mfma_f32_16x16x32_bf16 v[172:175], v[100:103], v[112:115], v[172:175]
v_mfma_f32_16x16x32_bf16 v[144:147], v[104:107], v[108:111], v[144:147]
v_mfma_f32_16x16x32_bf16 v[176:179], v[104:107], v[112:115], v[176:179]
s_cmp_eq_u32 s50, 15
s_cbranch_scc1 L_gate
s_nop 5
v_cvt_pk_bf16_f32 v36, v116, v117
v_cvt_pk_bf16_f32 v37, v118, v119
v_cvt_pk_bf16_f32 v38, v120, v121
v_cvt_pk_bf16_f32 v39, v122, v123
v_cvt_pk_bf16_f32 v52, v148, v149
v_cvt_pk_bf16_f32 v53, v150, v151
v_cvt_pk_bf16_f32 v54, v152, v153
v_cvt_pk_bf16_f32 v55, v154, v155
v_cvt_pk_bf16_f32 v40, v124, v125
v_cvt_pk_bf16_f32 v41, v126, v127
v_cvt_pk_bf16_f32 v42, v128, v129
v_cvt_pk_bf16_f32 v43, v130, v131
v_cvt_pk_bf16_f32 v56, v156, v157
v_cvt_pk_bf16_f32 v57, v158, v159
v_cvt_pk_bf16_f32 v58, v160, v161
v_cvt_pk_bf16_f32 v59, v162, v163
v_cvt_pk_bf16_f32 v44, v132, v133
v_cvt_pk_bf16_f32 v45, v134, v135
v_cvt_pk_bf16_f32 v46, v136, v137
v_cvt_pk_bf16_f32 v47, v138, v139
v_cvt_pk_bf16_f32 v60, v164, v165
v_cvt_pk_bf16_f32 v61, v166, v167
v_cvt_pk_bf16_f32 v62, v168, v169
v_cvt_pk_bf16_f32 v63, v170, v171
v_cvt_pk_bf16_f32 v48, v140, v141
v_cvt_pk_bf16_f32 v49, v142, v143
v_cvt_pk_bf16_f32 v50, v144, v145
v_cvt_pk_bf16_f32 v51, v146, v147
v_cvt_pk_bf16_f32 v64, v172, v173
v_cvt_pk_bf16_f32 v65, v174, v175
v_cvt_pk_bf16_f32 v66, v176, v177
v_cvt_pk_bf16_f32 v67, v178, v179
s_nop 1
v_mfma_f32_16x16x32_bf16 v[116:119], v[180:183], v[36:39], 0
v_mfma_f32_16x16x32_bf16 v[148:151], v[196:199], v[36:39], 0
v_mfma_f32_16x16x32_bf16 v[124:127], v[180:183], v[40:43], 0
v_mfma_f32_16x16x32_bf16 v[156:159], v[196:199], v[40:43], 0
v_mfma_f32_16x16x32_bf16 v[132:135], v[180:183], v[44:47], 0
v_mfma_f32_16x16x32_bf16 v[164:167], v[196:199], v[44:47], 0
v_mfma_f32_16x16x32_bf16 v[140:143], v[180:183], v[48:51], 0
v_mfma_f32_16x16x32_bf16 v[172:175], v[196:199], v[48:51], 0
v_mfma_f32_16x16x32_bf16 v[116:119], v[188:191], v[52:55], v[116:119]
v_mfma_f32_16x16x32_bf16 v[148:151], v[180:183], v[52:55], v[148:151]
v_mfma_f32_16x16x32_bf16 v[124:127], v[188:191], v[56:59], v[124:127]
v_mfma_f32_16x16x32_bf16 v[156:159], v[180:183], v[56:59], v[156:159]
v_mfma_f32_16x16x32_bf16 v[132:135], v[188:191], v[60:63], v[132:135]
v_mfma_f32_16x16x32_bf16 v[164:167], v[180:183], v[60:63], v[164:167]
v_mfma_f32_16x16x32_bf16 v[140:143], v[188:191], v[64:67], v[140:143]
v_mfma_f32_16x16x32_bf16 v[172:175], v[180:183], v[64:67], v[172:175]
v_mfma_f32_16x16x32_bf16 v[120:123], v[184:187], v[36:39], 0
v_mfma_f32_16x16x32_bf16 v[152:155], v[200:203], v[36:39], 0
v_mfma_f32_16x16x32_bf16 v[128:131], v[184:187], v[40:43], 0
v_mfma_f32_16x16x32_bf16 v[160:163], v[200:203], v[40:43], 0
v_mfma_f32_16x16x32_bf16 v[136:139], v[184:187], v[44:47], 0
v_mfma_f32_16x16x32_bf16 v[168:171], v[200:203], v[44:47], 0
v_mfma_f32_16x16x32_bf16 v[144:147], v[184:187], v[48:51], 0
v_mfma_f32_16x16x32_bf16 v[176:179], v[200:203], v[48:51], 0
v_mfma_f32_16x16x32_bf16 v[120:123], v[192:195], v[52:55], v[120:123]
v_mfma_f32_16x16x32_bf16 v[152:155], v[184:187], v[52:55], v[152:155]
v_mfma_f32_16x16x32_bf16 v[128:131], v[192:195], v[56:59], v[128:131]
v_mfma_f32_16x16x32_bf16 v[160:163], v[184:187], v[56:59], v[160:163]
v_mfma_f32_16x16x32_bf16 v[136:139], v[192:195], v[60:63], v[136:139]
v_mfma_f32_16x16x32_bf16 v[168:171], v[184:187], v[60:63], v[168:171]
v_mfma_f32_16x16x32_bf16 v[144:147], v[192:195], v[64:67], v[144:147]
v_mfma_f32_16x16x32_bf16 v[176:179], v[184:187], v[64:67], v[176:179]
v_cvt_pk_bf16_f32 v68, v116, v124
v_cvt_pk_bf16_f32 v69, v132, v140
v_cvt_pk_bf16_f32 v70, v148, v156
v_cvt_pk_bf16_f32 v71, v164, v172
s_mov_b32 s60, 0
buffer_store_dwordx4 v[68:71], v11, s[40:43], s60 offen sc1
v_cvt_pk_bf16_f32 v72, v117, v125
v_cvt_pk_bf16_f32 v73, v133, v141
v_cvt_pk_bf16_f32 v74, v149, v157
v_cvt_pk_bf16_f32 v75, v165, v173
s_mov_b32 s60, 65536
buffer_store_dwordx4 v[72:75], v11, s[40:43], s60 offen sc1
v_cvt_pk_bf16_f32 v76, v118, v126
v_cvt_pk_bf16_f32 v77, v134, v142
v_cvt_pk_bf16_f32 v78, v150, v158
v_cvt_pk_bf16_f32 v79, v166, v174
s_mov_b32 s60, 131072
buffer_store_dwordx4 v[76:79], v11, s[40:43], s60 offen sc1
v_cvt_pk_bf16_f32 v80, v119, v127
v_cvt_pk_bf16_f32 v81, v135, v143
v_cvt_pk_bf16_f32 v82, v151, v159
v_cvt_pk_bf16_f32 v83, v167, v175
s_mov_b32 s60, 196608
buffer_store_dwordx4 v[80:83], v11, s[40:43], s60 offen sc1
s_nop 0
v_cvt_pk_bf16_f32 v84, v120, v128
v_cvt_pk_bf16_f32 v85, v136, v144
v_cvt_pk_bf16_f32 v86, v152, v160
v_cvt_pk_bf16_f32 v87, v168, v176
s_mov_b32 s60, 1048576
buffer_store_dwordx4 v[84:87], v11, s[40:43], s60 offen sc1
v_cvt_pk_bf16_f32 v88, v121, v129
v_cvt_pk_bf16_f32 v89, v137, v145
v_cvt_pk_bf16_f32 v90, v153, v161
v_cvt_pk_bf16_f32 v91, v169, v177
s_mov_b32 s60, 1114112
buffer_store_dwordx4 v[88:91], v11, s[40:43], s60 offen sc1
v_cvt_pk_bf16_f32 v92, v122, v130
v_cvt_pk_bf16_f32 v93, v138, v146
v_cvt_pk_bf16_f32 v94, v154, v162
v_cvt_pk_bf16_f32 v95, v170, v178
s_mov_b32 s60, 1179648
buffer_store_dwordx4 v[92:95], v11, s[40:43], s60 offen sc1
v_cvt_pk_bf16_f32 v96, v123, v131
v_cvt_pk_bf16_f32 v97, v139, v147
v_cvt_pk_bf16_f32 v98, v155, v163
v_cvt_pk_bf16_f32 v99, v171, v179
s_mov_b32 s60, 1245184
buffer_store_dwordx4 v[96:99], v11, s[40:43], s60 offen sc1
s_branch L_k1_fin
L_gate:
s_nop 7
buffer_store_dwordx4 v[116:119], v12, s[40:43], 0 offen offset:0 sc1
buffer_store_dwordx4 v[120:123], v12, s[40:43], 0 offen offset:64 sc1
buffer_store_dwordx4 v[124:127], v12, s[40:43], 0 offen offset:256 sc1
buffer_store_dwordx4 v[128:131], v12, s[40:43], 0 offen offset:320 sc1
buffer_store_dwordx4 v[132:135], v12, s[40:43], 0 offen offset:512 sc1
buffer_store_dwordx4 v[136:139], v12, s[40:43], 0 offen offset:576 sc1
buffer_store_dwordx4 v[140:143], v12, s[40:43], 0 offen offset:768 sc1
buffer_store_dwordx4 v[144:147], v12, s[40:43], 0 offen offset:832 sc1
L_k1_fin:
v_add_u32 v84, 110592, v250
v_add_u32 v85, 110592, v251
v_add_u32 v86, 110592, v252
v_add_u32 v87, 110592, v253
s_waitcnt vmcnt(0)
v_readfirstlane_b32 s101, v205
s_cmp_lg_u32 s101, 0
s_cbranch_scc1 L_have
s_mov_b32 s74, 0x40000
L_renonce:
s_sub_u32 s74, s74, 1
s_cbranch_scc1 L_have
buffer_load_dword v205, off, s[24:27], 0 sc1
s_waitcnt vmcnt(0)
v_readfirstlane_b32 s101, v205
s_cmp_eq_u32 s101, 0
s_cbranch_scc1 L_renonce
L_have:
s_barrier
s_cmp_lg_u32 s44, 1
s_cbranch_scc1 L_noflag
v_mov_b32 v4, s101
s_mov_b32 exec_hi, 0
s_mov_b32 exec_lo, s3
buffer_store_dword v4, v242, s[40:43], 0 offen sc1
s_mov_b64 exec, -1
L_noflag:
s_cmp_lt_u32 s2, 32
s_cbranch_scc1 L_fin
s_mov_b64 s[62:63], -1
s_mov_b64 s[64:65], -1
s_mov_b32 s66, -1
s_mov_b32 s67, 0
s_mov_b32 s70, 0
s_mov_b32 s71, 2048
s_mov_b32 s72, 4096
ds_read_b64_tr_b16 a[0:1], v84 offset:0
ds_read_b64_tr_b16 a[2:3], v84 offset:2048
ds_read_b64_tr_b16 a[4:5], v85 offset:0
ds_read_b64_tr_b16 a[6:7], v85 offset:2048
ds_read_b64_tr_b16 a[8:9], v86 offset:0
ds_read_b64_tr_b16 a[10:11], v86 offset:2048
ds_read_b64_tr_b16 a[12:13], v87 offset:0
ds_read_b64_tr_b16 a[14:15], v87 offset:2048
ds_read_b64_tr_b16 a[16:17], v86 offset:3584
ds_read_b64_tr_b16 a[18:19], v86 offset:5632
ds_read_b64_tr_b16 a[20:21], v87 offset:3584
ds_read_b64_tr_b16 a[22:23], v87 offset:5632
ds_read_b64_tr_b16 a[24:25], v84 offset:3584
ds_read_b64_tr_b16 a[26:27], v84 offset:5632
ds_read_b64_tr_b16 a[28:29], v85 offset:3584
ds_read_b64_tr_b16 a[30:31], v85 offset:5632
ds_read_b64_tr_b16 a[32:33], v84 offset:7168
ds_read_b64_tr_b16 a[34:35], v84 offset:9216
ds_read_b64_tr_b16 a[36:37], v85 offset:7168
ds_read_b64_tr_b16 a[38:39], v85 offset:9216
ds_read_b64_tr_b16 a[40:41], v86 offset:7168
ds_read_b64_tr_b16 a[42:43], v86 offset:9216
ds_read_b64_tr_b16 a[44:45], v87 offset:7168
ds_read_b64_tr_b16 a[46:47], v87 offset:9216
ds_read_b64_tr_b16 a[48:49], v86 offset:10752
ds_read_b64_tr_b16 a[50:51], v86 offset:12800
ds_read_b64_tr_b16 a[52:53], v87 offset:10752
ds_read_b64_tr_b16 a[54:55], v87 offset:12800
ds_read_b64_tr_b16 a[56:57], v84 offset:10752
ds_read_b64_tr_b16 a[58:59], v84 offset:12800
ds_read_b64_tr_b16 a[60:61], v85 offset:10752
ds_read_b64_tr_b16 a[62:63], v85 offset:12800
ds_read_b64_tr_b16 a[64:65], v84 offset:14336
ds_read_b64_tr_b16 a[66:67], v84 offset:16384
ds_read_b64_tr_b16 a[68:69], v85 offset:14336
ds_read_b64_tr_b16 a[70:71], v85 offset:16384
ds_read_b64_tr_b16 a[72:73], v86 offset:14336
ds_read_b64_tr_b16 a[74:75], v86 offset:16384
ds_read_b64_tr_b16 a[76:77], v87 offset:14336
ds_read_b64_tr_b16 a[78:79], v87 offset:16384
ds_read_b64_tr_b16 a[80:81], v86 offset:17920
ds_read_b64_tr_b16 a[82:83], v86 offset:19968
ds_read_b64_tr_b16 a[84:85], v87 offset:17920
ds_read_b64_tr_b16 a[86:87], v87 offset:19968
ds_read_b64_tr_b16 a[88:89], v84 offset:17920
ds_read_b64_tr_b16 a[90:91], v84 offset:19968
ds_read_b64_tr_b16 a[92:93], v85 offset:17920
ds_read_b64_tr_b16 a[94:95], v85 offset:19968
ds_read_b64_tr_b16 a[96:97], v84 offset:21504
ds_read_b64_tr_b16 a[98:99], v84 offset:23552
ds_read_b64_tr_b16 a[100:101], v85 offset:21504
ds_read_b64_tr_b16 a[102:103], v85 offset:23552
ds_read_b64_tr_b16 a[104:105], v86 offset:21504
ds_read_b64_tr_b16 a[106:107], v86 offset:23552
ds_read_b64_tr_b16 a[108:109], v87 offset:21504
ds_read_b64_tr_b16 a[110:111], v87 offset:23552
ds_read_b64_tr_b16 a[112:113], v86 offset:25088
ds_read_b64_tr_b16 a[114:115], v86 offset:27136
ds_read_b64_tr_b16 a[116:117], v87 offset:25088
ds_read_b64_tr_b16 a[118:119], v87 offset:27136
ds_read_b64_tr_b16 a[120:121], v84 offset:25088
ds_read_b64_tr_b16 a[122:123], v84 offset:27136
ds_read_b64_tr_b16 a[124:125], v85 offset:25088
ds_read_b64_tr_b16 a[126:127], v85 offset:27136
ds_read_b64_tr_b16 a[128:129], v250 offset:0
ds_read_b64_tr_b16 a[130:131], v250 offset:2048
ds_read_b64_tr_b16 a[132:133], v251 offset:0
ds_read_b64_tr_b16 a[134:135], v251 offset:2048
ds_read_b64_tr_b16 a[136:137], v252 offset:0
ds_read_b64_tr_b16 a[138:139], v252 offset:2048
ds_read_b64_tr_b16 a[140:141], v253 offset:0
ds_read_b64_tr_b16 a[142:143], v253 offset:2048
ds_read_b64_tr_b16 a[144:145], v252 offset:3584
ds_read_b64_tr_b16 a[146:147], v252 offset:5632
ds_read_b64_tr_b16 a[148:149], v253 offset:3584
ds_read_b64_tr_b16 a[150:151], v253 offset:5632
ds_read_b64_tr_b16 a[152:153], v250 offset:3584
ds_read_b64_tr_b16 a[154:155], v250 offset:5632
ds_read_b64_tr_b16 a[156:157], v251 offset:3584
ds_read_b64_tr_b16 a[158:159], v251 offset:5632
ds_read_b64_tr_b16 a[160:161], v250 offset:7168
ds_read_b64_tr_b16 a[162:163], v250 offset:9216
ds_read_b64_tr_b16 a[164:165], v251 offset:7168
ds_read_b64_tr_b16 a[166:167], v251 offset:9216
ds_read_b64_tr_b16 a[168:169], v252 offset:7168
ds_read_b64_tr_b16 a[170:171], v252 offset:9216
ds_read_b64_tr_b16 a[172:173], v253 offset:7168
ds_read_b64_tr_b16 a[174:175], v253 offset:9216
ds_read_b64_tr_b16 a[176:177], v252 offset:10752
ds_read_b64_tr_b16 a[178:179], v252 offset:12800
ds_read_b64_tr_b16 a[180:181], v253 offset:10752
ds_read_b64_tr_b16 a[182:183], v253 offset:12800
ds_read_b64_tr_b16 a[184:185], v250 offset:10752
ds_read_b64_tr_b16 a[186:187], v250 offset:12800
ds_read_b64_tr_b16 a[188:189], v251 offset:10752
ds_read_b64_tr_b16 a[190:191], v251 offset:12800
ds_read_b64_tr_b16 a[192:193], v250 offset:14336
ds_read_b64_tr_b16 a[194:195], v250 offset:16384
ds_read_b64_tr_b16 a[196:197], v251 offset:14336
ds_read_b64_tr_b16 a[198:199], v251 offset:16384
ds_read_b64_tr_b16 a[200:201], v252 offset:14336
ds_read_b64_tr_b16 a[202:203], v252 offset:16384
ds_read_b64_tr_b16 a[204:205], v253 offset:14336
ds_read_b64_tr_b16 a[206:207], v253 offset:16384
ds_read_b64_tr_b16 a[208:209], v252 offset:17920
ds_read_b64_tr_b16 a[210:211], v252 offset:19968
ds_read_b64_tr_b16 a[212:213], v253 offset:17920
ds_read_b64_tr_b16 a[214:215], v253 offset:19968
ds_read_b64_tr_b16 a[216:217], v250 offset:17920
ds_read_b64_tr_b16 a[218:219], v250 offset:19968
ds_read_b64_tr_b16 a[220:221], v251 offset:17920
ds_read_b64_tr_b16 a[222:223], v251 offset:19968
s_cmp_lg_u32 s44, 0
s_cbranch_scc1 L_p0
s_mov_b64 exec, s[62:63]
buffer_load_dword v124, v240, s[40:43], s70 offen sc1
s_mov_b64 exec, s[64:65]
buffer_load_dword v125, v240, s[40:43], s71 offen sc1
s_mov_b64 exec, s[66:67]
buffer_load_dword v126, v240, s[40:43], s72 offen sc1
s_mov_b64 exec, -1
L_p0:
ds_read_b64_tr_b16 a[224:225], v250 offset:21504
ds_read_b64_tr_b16 a[226:227], v250 offset:23552
ds_read_b64_tr_b16 a[228:229], v251 offset:21504
ds_read_b64_tr_b16 a[230:231], v251 offset:23552
ds_read_b64_tr_b16 a[232:233], v252 offset:21504
ds_read_b64_tr_b16 a[234:235], v252 offset:23552
ds_read_b64_tr_b16 a[236:237], v253 offset:21504
ds_read_b64_tr_b16 a[238:239], v253 offset:23552
ds_read_b64_tr_b16 a[240:241], v252 offset:25088
ds_read_b64_tr_b16 a[242:243], v252 offset:27136
ds_read_b64_tr_b16 a[244:245], v253 offset:25088
ds_read_b64_tr_b16 a[246:247], v253 offset:27136
ds_read_b64_tr_b16 a[248:249], v250 offset:25088
ds_read_b64_tr_b16 a[250:251], v250 offset:27136
ds_read_b64_tr_b16 a[252:253], v251 offset:25088
ds_read_b64_tr_b16 a[254:255], v251 offset:27136
s_cmp_lg_u32 s44, 0
s_cbranch_scc1 L_go
s_mov_b32 s74, 0x40000
L_pa:
s_waitcnt vmcnt(0)
s_mov_b64 exec, s[62:63]
v_cmp_ne_u32 s[62:63], s101, v124
s_mov_b64 exec, s[64:65]
v_cmp_ne_u32 s[64:65], s101, v125
s_mov_b64 exec, s[66:67]
v_cmp_ne_u32 s[66:67], s101, v126
s_or_b32 s68, s65, s66
s_cbranch_scc0 L_pa_x
s_mov_b64 exec, s[62:63]
buffer_load_dword v124, v240, s[40:43], s70 offen sc1
s_mov_b64 exec, s[64:65]
buffer_load_dword v125, v240, s[40:43], s71 offen sc1
s_mov_b64 exec, s[66:67]
buffer_load_dword v126, v240, s[40:43], s72 offen sc1
s_sub_u32 s74, s74, 1
s_cbranch_scc0 L_pa
L_pa_x:
s_mov_b64 exec, -1
v_mov_b32 v120, 32768
v_mov_b32 v121, s101
ds_write_b32 v120, v121
s_mov_b64 exec, s[62:63]
buffer_load_dword v124, v240, s[40:43], s70 offen sc1
s_mov_b64 exec, s[64:65]
buffer_load_dword v125, v240, s[40:43], s71 offen sc1
s_mov_b64 exec, s[66:67]
buffer_load_dword v126, v240, s[40:43], s72 offen sc1
s_mov_b64 exec, -1
s_add_u32 m0, s16, 0
s_mov_b32 s60, 0
buffer_load_dwordx4 v244, s[40:43], s60 offen sc1 lds
s_add_u32 m0, s16, 1024
s_mov_b32 s60, 16384
buffer_load_dwordx4 v244, s[40:43], s60 offen sc1 lds
s_add_u32 m0, s16, 2048
s_mov_b32 s60, 32768
buffer_load_dwordx4 v244, s[40:43], s60 offen sc1 lds
s_add_u32 m0, s16, 3072
s_mov_b32 s60, 49152
buffer_load_dwordx4 v244, s[40:43], s60 offen sc1 lds
s_mov_b32 s74, 0x40000
s_waitcnt vmcnt(4)
s_branch L_pb_c
L_pb:
s_waitcnt vmcnt(0)
L_pb_c:
s_mov_b64 exec, s[62:63]
v_cmp_ne_u32 s[62:63], s101, v124
s_mov_b64 exec, s[64:65]
v_cmp_ne_u32 s[64:65], s101, v125
s_mov_b64 exec, s[66:67]
v_cmp_ne_u32 s[66:67], s101, v126
s_or_b64 s[68:69], s[62:63], s[64:65]
s_or_b64 s[68:69], s[68:69], s[66:67]
s_cbranch_scc0 L_pb_x
s_mov_b64 exec, s[62:63]
buffer_load_dword v124, v240, s[40:43], s70 offen sc1
s_mov_b64 exec, s[64:65]
buffer_load_dword v125, v240, s[40:43], s71 offen sc1
s_mov_b64 exec, s[66:67]
buffer_load_dword v126, v240, s[40:43], s72 offen sc1
s_sub_u32 s74, s74, 1
s_cbranch_scc0 L_pb
L_pb_x:
s_mov_b64 exec, -1
s_branch L_go2
L_go:
v_mov_b32 v120, 32768
s_mov_b32 s74, 0x400000
L_ls:
ds_read_b32 v121, v120
s_sub_u32 s74, s74, 1
s_cbranch_scc1 L_ls_x
s_waitcnt lgkmcnt(0)
v_readfirstlane_b32 s75, v121
s_cmp_lg_u32 s75, s101
s_cbranch_scc1 L_ls
L_ls_x:
s_add_u32 m0, s16, 0
s_mov_b32 s60, 0
buffer_load_dwordx4 v244, s[40:43], s60 offen sc1 lds
s_add_u32 m0, s16, 1024
s_mov_b32 s60, 16384
buffer_load_dwordx4 v244, s[40:43], s60 offen sc1 lds
s_add_u32 m0, s16, 2048
s_mov_b32 s60, 32768
buffer_load_dwordx4 v244, s[40:43], s60 offen sc1 lds
s_add_u32 m0, s16, 3072
s_mov_b32 s60, 49152
buffer_load_dwordx4 v244, s[40:43], s60 offen sc1 lds
L_go2:
s_waitcnt lgkmcnt(0)
s_barrier
buffer_load_dword v27, v246, s[40:43], 0 offen sc1
s_add_u32 m0, s15, 0
s_nop 0
buffer_load_dwordx4 v245, s[40:43], 0 offen offset:0 sc1 lds
s_add_u32 m0, s15, 1024
s_nop 0
buffer_load_dwordx4 v249, s[40:43], 0 offen offset:0 sc1 lds
s_add_u32 m0, s15, 1920
s_nop 0
buffer_load_dwordx4 v245, s[40:43], 0 offen offset:128 sc1 lds
s_add_u32 m0, s15, 2944
s_nop 0
buffer_load_dwordx4 v249, s[40:43], 0 offen offset:128 sc1 lds
s_add_u32 m0, s15, 3840
s_nop 0
buffer_load_dwordx4 v245, s[40:43], 0 offen offset:256 sc1 lds
s_add_u32 m0, s15, 4864
s_nop 0
buffer_load_dwordx4 v249, s[40:43], 0 offen offset:256 sc1 lds
s_waitcnt vmcnt(7)
s_barrier
ds_read_b128 v[60:63], v254 offset:0
ds_read_b128 v[64:67], v254 offset:4096
ds_read_b128 v[68:71], v254 offset:8192
ds_read_b128 v[72:75], v254 offset:12288
s_add_u32 m0, s15, 5760
s_nop 0
buffer_load_dwordx4 v245, s[40:43], 0 offen offset:384 sc1 lds
s_waitcnt lgkmcnt(3)
v_mfma_f32_16x16x32_bf16 v[92:95], v[60:63], v[208:211], 0
ds_read_b128 v[76:79], v254 offset:1024
ds_read_b128 v[80:83], v254 offset:5120
s_waitcnt lgkmcnt(4)
s_add_u32 m0, s15, 6784
s_nop 0
buffer_load_dwordx4 v249, s[40:43], 0 offen offset:384 sc1 lds
v_mfma_f32_16x16x32_bf16 v[96:99], v[64:67], v[208:211], 0
ds_read_b128 v[84:87], v254 offset:9216
ds_read_b128 v[88:91], v254 offset:13312
s_waitcnt lgkmcnt(5)
v_mfma_f32_16x16x32_bf16 v[100:103], v[68:71], v[224:227], 0
s_add_u32 m0, s15, 7680
s_nop 0
buffer_load_dwordx4 v245, s[40:43], 0 offen offset:512 sc1 lds
s_waitcnt lgkmcnt(4)
v_mfma_f32_16x16x32_bf16 v[104:107], v[72:75], v[224:227], 0
s_waitcnt lgkmcnt(3)
v_mfma_f32_16x16x32_bf16 v[92:95], v[76:79], v[212:215], v[92:95]
ds_read_b128 v[60:63], v254 offset:2048
s_add_u32 m0, s15, 8704
s_nop 0
buffer_load_dwordx4 v249, s[40:43], 0 offen offset:512 sc1 lds
ds_read_b128 v[64:67], v254 offset:6144
s_waitcnt lgkmcnt(4)
v_mfma_f32_16x16x32_bf16 v[96:99], v[80:83], v[212:215], v[96:99]
ds_read_b128 v[68:71], v254 offset:10240
ds_read_b128 v[72:75], v254 offset:14336
s_add_u32 m0, s15, 9600
s_nop 0
buffer_load_dwordx4 v245, s[40:43], 0 offen offset:640 sc1 lds
s_waitcnt lgkmcnt(5)
v_mfma_f32_16x16x32_bf16 v[100:103], v[84:87], v[228:231], v[100:103]
s_waitcnt lgkmcnt(4)
v_mfma_f32_16x16x32_bf16 v[104:107], v[88:91], v[228:231], v[104:107]
s_add_u32 m0, s15, 10624
s_nop 0
buffer_load_dwordx4 v249, s[40:43], 0 offen offset:640 sc1 lds
s_waitcnt lgkmcnt(3)
v_mfma_f32_16x16x32_bf16 v[92:95], v[60:63], v[216:219], v[92:95]
ds_read_b128 v[76:79], v254 offset:3072
ds_read_b128 v[80:83], v254 offset:7168
s_waitcnt lgkmcnt(4)
s_add_u32 m0, s15, 11520
s_nop 0
buffer_load_dwordx4 v245, s[40:43], 0 offen offset:768 sc1 lds
v_mfma_f32_16x16x32_bf16 v[96:99], v[64:67], v[216:219], v[96:99]
ds_read_b128 v[84:87], v254 offset:11264
ds_read_b128 v[88:91], v254 offset:15360
s_waitcnt lgkmcnt(5)
v_mfma_f32_16x16x32_bf16 v[100:103], v[68:71], v[232:235], v[100:103]
s_add_u32 m0, s15, 12544
s_nop 0
buffer_load_dwordx4 v249, s[40:43], 0 offen offset:768 sc1 lds
s_waitcnt lgkmcnt(4)
v_mfma_f32_16x16x32_bf16 v[104:107], v[72:75], v[232:235], v[104:107]
s_waitcnt lgkmcnt(3)
v_mfma_f32_16x16x32_bf16 v[92:95], v[76:79], v[220:223], v[92:95]
s_waitcnt lgkmcnt(2)
s_add_u32 m0, s15, 13440
s_nop 0
buffer_load_dwordx4 v245, s[40:43], 0 offen offset:896 sc1 lds
v_mfma_f32_16x16x32_bf16 v[96:99], v[80:83], v[220:223], v[96:99]
s_waitcnt lgkmcnt(1)
v_mfma_f32_16x16x32_bf16 v[100:103], v[84:87], v[236:239], v[100:103]
s_waitcnt lgkmcnt(0)
v_mfma_f32_16x16x32_bf16 v[104:107], v[88:91], v[236:239], v[104:107]
s_add_u32 m0, s15, 14464
s_nop 0
buffer_load_dwordx4 v249, s[40:43], 0 offen offset:896 sc1 lds
s_waitcnt vmcnt(14)
ds_read_b128 v[124:127], v241 offset:0
ds_read_b128 v[128:131], v243 offset:0
s_waitcnt lgkmcnt(1)
v_mfma_f32_16x16x32_bf16 v[108:111], a[0:3], v[124:127], 0
v_mfma_f32_16x16x32_bf16 v[112:115], a[4:7], v[124:127], 0
s_waitcnt vmcnt(12)
ds_read_b128 v[132:135], v241 offset:2048
ds_read_b128 v[136:139], v243 offset:2048
v_mfma_f32_16x16x32_bf16 v[116:119], a[8:11], v[124:127], 0
v_mfma_f32_16x16x32_bf16 v[120:123], a[12:15], v[124:127], 0
s_waitcnt lgkmcnt(2)
v_mfma_f32_16x16x32_bf16 v[108:111], a[16:19], v[128:131], v[108:111]
v_mfma_f32_16x16x32_bf16 v[112:115], a[20:23], v[128:131], v[112:115]
v_mfma_f32_16x16x32_bf16 v[116:119], a[24:27], v[128:131], v[116:119]
v_mfma_f32_16x16x32_bf16 v[120:123], a[28:31], v[128:131], v[120:123]
s_waitcnt lgkmcnt(1)
v_mfma_f32_16x16x32_bf16 v[108:111], a[32:35], v[132:135], v[108:111]
v_mfma_f32_16x16x32_bf16 v[112:115], a[36:39], v[132:135], v[112:115]
s_waitcnt vmcnt(10)
ds_read_b128 v[140:143], v241 offset:4096
ds_read_b128 v[144:147], v243 offset:4096
v_mfma_f32_16x16x32_bf16 v[116:119], a[40:43], v[132:135], v[116:119]
v_mfma_f32_16x16x32_bf16 v[120:123], a[44:47], v[132:135], v[120:123]
s_waitcnt lgkmcnt(2)
v_mfma_f32_16x16x32_bf16 v[108:111], a[48:51], v[136:139], v[108:111]
v_mfma_f32_16x16x32_bf16 v[112:115], a[52:55], v[136:139], v[112:115]
v_mfma_f32_16x16x32_bf16 v[116:119], a[56:59], v[136:139], v[116:119]
v_mfma_f32_16x16x32_bf16 v[120:123], a[60:63], v[136:139], v[120:123]
s_waitcnt lgkmcnt(1)
v_mfma_f32_16x16x32_bf16 v[108:111], a[64:67], v[140:143], v[108:111]
v_mfma_f32_16x16x32_bf16 v[112:115], a[68:71], v[140:143], v[112:115]
s_waitcnt vmcnt(8)
ds_read_b128 v[148:151], v241 offset:6144
ds_read_b128 v[152:155], v243 offset:6144
v_mfma_f32_16x16x32_bf16 v[116:119], a[72:75], v[140:143], v[116:119]
v_mfma_f32_16x16x32_bf16 v[120:123], a[76:79], v[140:143], v[120:123]
s_waitcnt lgkmcnt(2)
v_mfma_f32_16x16x32_bf16 v[108:111], a[80:83], v[144:147], v[108:111]
v_mfma_f32_16x16x32_bf16 v[112:115], a[84:87], v[144:147], v[112:115]
v_mfma_f32_16x16x32_bf16 v[116:119], a[88:91], v[144:147], v[116:119]
v_mfma_f32_16x16x32_bf16 v[120:123], a[92:95], v[144:147], v[120:123]
s_waitcnt lgkmcnt(1)
v_mfma_f32_16x16x32_bf16 v[108:111], a[96:99], v[148:151], v[108:111]
v_mfma_f32_16x16x32_bf16 v[112:115], a[100:103], v[148:151], v[112:115]
s_waitcnt vmcnt(6)
ds_read_b128 v[156:159], v241 offset:8192
ds_read_b128 v[160:163], v243 offset:8192
v_mfma_f32_16x16x32_bf16 v[116:119], a[104:107], v[148:151], v[116:119]
v_mfma_f32_16x16x32_bf16 v[120:123], a[108:111], v[148:151], v[120:123]
s_waitcnt lgkmcnt(2)
v_mfma_f32_16x16x32_bf16 v[108:111], a[112:115], v[152:155], v[108:111]
v_mfma_f32_16x16x32_bf16 v[112:115], a[116:119], v[152:155], v[112:115]
v_mfma_f32_16x16x32_bf16 v[116:119], a[120:123], v[152:155], v[116:119]
v_mfma_f32_16x16x32_bf16 v[120:123], a[124:127], v[152:155], v[120:123]
s_waitcnt lgkmcnt(1)
v_mfma_f32_16x16x32_bf16 v[108:111], a[128:131], v[156:159], v[108:111]
v_mfma_f32_16x16x32_bf16 v[112:115], a[132:135], v[156:159], v[112:115]
s_waitcnt vmcnt(4)
ds_read_b128 v[164:167], v241 offset:10240
ds_read_b128 v[168:171], v243 offset:10240
v_mfma_f32_16x16x32_bf16 v[116:119], a[136:139], v[156:159], v[116:119]
v_mfma_f32_16x16x32_bf16 v[120:123], a[140:143], v[156:159], v[120:123]
s_waitcnt lgkmcnt(2)
v_mfma_f32_16x16x32_bf16 v[108:111], a[144:147], v[160:163], v[108:111]
v_mfma_f32_16x16x32_bf16 v[112:115], a[148:151], v[160:163], v[112:115]
v_mfma_f32_16x16x32_bf16 v[116:119], a[152:155], v[160:163], v[116:119]
v_mfma_f32_16x16x32_bf16 v[120:123], a[156:159], v[160:163], v[120:123]
s_waitcnt lgkmcnt(1)
v_mfma_f32_16x16x32_bf16 v[108:111], a[160:163], v[164:167], v[108:111]
v_mfma_f32_16x16x32_bf16 v[112:115], a[164:167], v[164:167], v[112:115]
s_waitcnt vmcnt(2)
ds_read_b128 v[172:175], v241 offset:12288
ds_read_b128 v[176:179], v243 offset:12288
v_mfma_f32_16x16x32_bf16 v[116:119], a[168:171], v[164:167], v[116:119]
v_mfma_f32_16x16x32_bf16 v[120:123], a[172:175], v[164:167], v[120:123]
s_waitcnt lgkmcnt(2)
v_mfma_f32_16x16x32_bf16 v[108:111], a[176:179], v[168:171], v[108:111]
v_mfma_f32_16x16x32_bf16 v[112:115], a[180:183], v[168:171], v[112:115]
v_mfma_f32_16x16x32_bf16 v[116:119], a[184:187], v[168:171], v[116:119]
v_mfma_f32_16x16x32_bf16 v[120:123], a[188:191], v[168:171], v[120:123]
s_waitcnt lgkmcnt(1)
v_mfma_f32_16x16x32_bf16 v[108:111], a[192:195], v[172:175], v[108:111]
v_mfma_f32_16x16x32_bf16 v[112:115], a[196:199], v[172:175], v[112:115]
s_waitcnt vmcnt(0)
ds_read_b128 v[180:183], v241 offset:14336
ds_read_b128 v[184:187], v243 offset:14336
v_mfma_f32_16x16x32_bf16 v[116:119], a[200:203], v[172:175], v[116:119]
v_mfma_f32_16x16x32_bf16 v[120:123], a[204:207], v[172:175], v[120:123]
s_waitcnt lgkmcnt(2)
v_mfma_f32_16x16x32_bf16 v[108:111], a[208:211], v[176:179], v[108:111]
v_mfma_f32_16x16x32_bf16 v[112:115], a[212:215], v[176:179], v[112:115]
v_mfma_f32_16x16x32_bf16 v[116:119], a[216:219], v[176:179], v[116:119]
v_mfma_f32_16x16x32_bf16 v[120:123], a[220:223], v[176:179], v[120:123]
s_waitcnt lgkmcnt(1)
v_mfma_f32_16x16x32_bf16 v[108:111], a[224:227], v[180:183], v[108:111]
v_mfma_f32_16x16x32_bf16 v[112:115], a[228:231], v[180:183], v[112:115]
v_mfma_f32_16x16x32_bf16 v[116:119], a[232:235], v[180:183], v[116:119]
v_mfma_f32_16x16x32_bf16 v[120:123], a[236:239], v[180:183], v[120:123]
s_waitcnt lgkmcnt(0)
v_mfma_f32_16x16x32_bf16 v[108:111], a[240:243], v[184:187], v[108:111]
v_mfma_f32_16x16x32_bf16 v[112:115], a[244:247], v[184:187], v[112:115]
v_mfma_f32_16x16x32_bf16 v[116:119], a[248:251], v[184:187], v[116:119]
v_mfma_f32_16x16x32_bf16 v[120:123], a[252:255], v[184:187], v[120:123]
v_mul_f32 v27, 0xbfb8aa3b, v27
v_exp_f32 v27, v27
s_nop 0
v_add_f32 v27, 1.0, v27
v_rcp_f32 v27, v27
s_nop 3
v_sub_f32 v92, v92, v108
v_sub_f32 v93, v93, v109
v_sub_f32 v94, v94, v110
v_sub_f32 v95, v95, v111
v_fma_f32 v92, v92, v27, v108
v_fma_f32 v93, v93, v27, v109
v_fma_f32 v94, v94, v27, v110
v_fma_f32 v95, v95, v27, v111
v_cvt_pk_bf16_f32 v60, v92, v93
v_cvt_pk_bf16_f32 v61, v94, v95
buffer_store_dwordx2 v[60:61], v247, s[20:23], 0 offen offset:0
v_sub_f32 v96, v96, v112
v_sub_f32 v97, v97, v113
v_sub_f32 v98, v98, v114
v_sub_f32 v99, v99, v115
v_fma_f32 v96, v96, v27, v112
v_fma_f32 v97, v97, v27, v113
v_fma_f32 v98, v98, v27, v114
v_fma_f32 v99, v99, v27, v115
v_cvt_pk_bf16_f32 v62, v96, v97
v_cvt_pk_bf16_f32 v63, v98, v99
buffer_store_dwordx2 v[62:63], v247, s[20:23], 0 offen offset:32
v_sub_f32 v100, v100, v116
v_sub_f32 v101, v101, v117
v_sub_f32 v102, v102, v118
v_sub_f32 v103, v103, v119
v_fma_f32 v100, v100, v27, v116
v_fma_f32 v101, v101, v27, v117
v_fma_f32 v102, v102, v27, v118
v_fma_f32 v103, v103, v27, v119
v_cvt_pk_bf16_f32 v64, v100, v101
v_cvt_pk_bf16_f32 v65, v102, v103
buffer_store_dwordx2 v[64:65], v247, s[20:23], 0 offen offset:64
v_sub_f32 v104, v104, v120
v_sub_f32 v105, v105, v121
v_sub_f32 v106, v106, v122
v_sub_f32 v107, v107, v123
v_fma_f32 v104, v104, v27, v120
v_fma_f32 v105, v105, v27, v121
v_fma_f32 v106, v106, v27, v122
v_fma_f32 v107, v107, v27, v123
v_cvt_pk_bf16_f32 v66, v104, v105
v_cvt_pk_bf16_f32 v67, v106, v107
buffer_store_dwordx2 v[66:67], v247, s[20:23], 0 offen offset:96
L_fin:
L_end:
s_endpgm
.section .rodata,"a"
.p2align 6
.amdhsa_kernel gated_mix__spectral_fnet__sliding_local_dilated__prompt_kernel
  .amdhsa_next_free_vgpr 512
  .amdhsa_next_free_sgpr 102
  .amdhsa_accum_offset 256
  .amdhsa_group_segment_fixed_size 0
  .amdhsa_kernarg_size 96
  .amdhsa_user_sgpr_count 2
  .amdhsa_user_sgpr_kernarg_segment_ptr 1
  .amdhsa_system_sgpr_workgroup_id_x 1
.end_amdhsa_kernel
```
